```python
import torch

def _softmax(x, axis=-1):
    return torch.softmax(x, dim=axis)
def _gelu(x):
    return torch.nn.functional.gelu(x, approximate="tanh")
def _silu(x):
    return torch.nn.functional.silu(x)
def _sigmoid(x):
    return torch.sigmoid(x)
def _layernorm(x, axis=-1, eps=1e-5):
    m = x.mean(dim=axis, keepdim=True)
    v = x.var(dim=axis, keepdim=True, unbiased=False)
    return (x - m) / torch.sqrt(v + eps)
def _scatter_add(tgt, idx, src, axis=0):
    return tgt.clone().index_add_(axis, idx, src)
def _segment_sum(src, seg, n):
    out = torch.zeros((n,) + src.shape[1:], dtype=src.dtype)
    return out.index_add_(0, seg, src)
def _pad(x, pw):
    flat = tuple(v for pair in reversed(pw) for v in pair)
    return torch.nn.functional.pad(x, flat)

kernel_name = 'concat_heads__gqa_block_cached__mha_block_cached__decode'

def setup_inputs():

    _w = (lambda a: (lambda t: t.to(torch.bfloat16) if t.is_floating_point() else t)(torch.as_tensor(a)))
    def _A_setup():
        B, Sq, D = 2, 1, 640
        Hq, Hkv, Sk, Dh = 32, 32, 8192, 192
        assert Hq % Hkv == 0, (Hq, Hkv)
        return {
            "x": _w((lambda *s: torch.randn(*s, dtype=torch.bfloat16) * 0.8)(B, Sq, D)),
            "k_cache": _w((lambda *s: torch.randn(*s, dtype=torch.bfloat16) * 0.8)(B, Hkv, Sk, Dh)),
            "v_cache": _w((lambda *s: torch.randn(*s, dtype=torch.bfloat16) * 0.05)(B, Hkv, Sk, Dh)),
            "wq": _w((lambda *s: torch.randn(*s, dtype=torch.bfloat16) * 0.8)(D, Hq * Dh) * (D ** -0.5)),
            "wo": _w((lambda *s: torch.randn(*s, dtype=torch.bfloat16) * 0.05)(Hq * Dh, D) * ((Hq * Dh) ** -0.5)),
        }
    _A_in = _A_setup()

    def _B_setup():
        B, Sq, D = 2, 1, 640
        H, Sk, Dh = 32, 8192, 192
        return {
            "x": _w((lambda *s: torch.randn(*s, dtype=torch.bfloat16) * 0.8)(B, Sq, D)),
            "k_cache": _w((lambda *s: torch.randn(*s, dtype=torch.bfloat16) * 0.8)(B, H, Sk, Dh)),
            "v_cache": _w((lambda *s: torch.randn(*s, dtype=torch.bfloat16) * 0.05)(B, H, Sk, Dh)),
            "wq": _w((lambda *s: torch.randn(*s, dtype=torch.bfloat16) * 0.8)(D, H * Dh) * (D ** -0.5)),
            "wo": _w((lambda *s: torch.randn(*s, dtype=torch.bfloat16) * 0.05)(H * Dh, D) * ((H * Dh) ** -0.5)),
        }
    _B_in = _B_setup()

    return {
        "A_x": _A_in["x"],
        "A_k_cache": _A_in["k_cache"],
        "A_v_cache": _A_in["v_cache"],
        "A_wq": _A_in["wq"],
        "A_wo": _A_in["wo"],
        "B_x": _B_in["x"],
        "B_k_cache": _B_in["k_cache"],
        "B_v_cache": _B_in["v_cache"],
        "B_wq": _B_in["wq"],
        "B_wo": _B_in["wo"],
    }

def reference(A_x, A_k_cache, A_v_cache, A_wq, A_wo, B_x, B_k_cache, B_v_cache, B_wq, B_wo):
    def _A_ref(x, k_cache, v_cache, wq, wo):
        B, Sq, D = x.shape
        Hq, Dh = 32, 192
        Hkv = k_cache.shape[1]
        rep = Hq // Hkv
        q = (lambda x, *d: x.permute(*d))((x @ wq).reshape(B, Sq, Hq, Dh), 0, 2, 1, 3)
        k = (lambda x, n, axis: torch.repeat_interleave(x, n, dim=axis))(k_cache, rep, axis=1)
        v = (lambda x, n, axis: torch.repeat_interleave(x, n, dim=axis))(v_cache, rep, axis=1)
        scores = torch.einsum("bhqd,bhkd->bhqk", q, k) * (Dh ** -0.5)
        p = _softmax(scores, axis=-1)
        o = torch.einsum("bhqk,bhkd->bhqd", p, v)
        return (lambda x, *d: x.permute(*d))(o, 0, 2, 1, 3).reshape(B, Sq, Hq * Dh) @ wo

    def _B_ref(x, k_cache, v_cache, wq, wo):
        B, Sq, D = x.shape
        H, Dh = 32, 192
        q = (lambda x, *d: x.permute(*d))((x @ wq).reshape(B, Sq, H, Dh), 0, 2, 1, 3)
        scores = torch.einsum("bhqd,bhkd->bhqk", q, k_cache) * (Dh ** -0.5)
        p = _softmax(scores, axis=-1)
        o = torch.einsum("bhqk,bhkd->bhqd", p, v_cache)
        return (lambda x, *d: x.permute(*d))(o, 0, 2, 1, 3).reshape(B, Sq, H * Dh) @ wo

    a = _A_ref(A_x, A_k_cache, A_v_cache, A_wq, A_wo)
    b = _B_ref(B_x, B_k_cache, B_v_cache, B_wq, B_wo)
    return torch.concatenate([a, b], axis=-1)
```

```asm
; @launch grid=(256,1,1) block=(320,1,1) lds=119296
.amdgcn_target "amdgcn-amd-amdhsa--gfx950"
.text
.globl concat_heads__gqa_block_cached__mha_block_cached__decode_kernel
.p2align 8
.type concat_heads__gqa_block_cached__mha_block_cached__decode_kernel,@function
concat_heads__gqa_block_cached__mha_block_cached__decode_kernel:
  s_cmp_ge_u32 s2, 256
  s_cbranch_scc1 L_end
  s_load_dwordx16 s[64:79], s[0:1], 0
  s_load_dwordx4 s[80:83], s[0:1], 64
  s_load_dwordx4 s[40:43], s[0:1], 88
  v_lshrrev_b32 v5, 6, v0
  v_and_b32 v1, 63, v0
  v_readfirstlane_b32 s5, v5
  v_lshrrev_b32 v6, 3, v1
  v_and_b32 v7, 7, v1
  s_and_b32 s3, s2, 7
  s_lshr_b32 s4, s2, 3
  s_cmp_eq_u32 s5, 4
  s_cbranch_scc1 L_tag
  v_mul_u32_u24 v3, 245760, v6
  v_lshl_add_u32 v3, v7, 4, v3
  s_and_b32 s28, s2, 31
  s_mul_i32 s28, s28, 3
  s_lshr_b32 s47, s2, 6
  s_add_u32 s28, s28, s47
  s_lshl_b32 s28, s28, 7
  s_mul_i32 s47, s5, 1966080
  s_add_u32 s28, s28, s47
  s_mov_b32 s26, 7864320
  s_mov_b32 s27, 0x20000
  s_bitcmp1_b32 s2, 5
  s_waitcnt lgkmcnt(0)
  s_cselect_b32 s24, s80, s70
  s_cselect_b32 s25, s81, s71
  s_cselect_b32 s32, s74, s64
  s_cselect_b32 s33, s75, s65
  s_cmp_ge_u32 s4, 24
  s_cbranch_scc1 L_noq
  buffer_load_dwordx4 a[0:3], v3, s[24:27], s28 offen nt
  s_addk_i32 s28, 12288
  buffer_load_dwordx4 a[4:7], v3, s[24:27], s28 offen nt
  s_addk_i32 s28, 12288
  buffer_load_dwordx4 a[8:11], v3, s[24:27], s28 offen nt
  s_addk_i32 s28, 12288
  buffer_load_dwordx4 a[12:15], v3, s[24:27], s28 offen nt
  s_addk_i32 s28, 12288
  buffer_load_dwordx4 a[16:19], v3, s[24:27], s28 offen nt
  s_addk_i32 s28, 12288
  buffer_load_dwordx4 a[20:23], v3, s[24:27], s28 offen nt
  s_addk_i32 s28, 12288
  buffer_load_dwordx4 a[24:27], v3, s[24:27], s28 offen nt
  s_addk_i32 s28, 12288
  s_branch L_xld
L_tag:
  s_memrealtime s[48:49]
  v_mov_b32 v4, 0
  s_mov_b32 s10, 256
  s_mov_b32 s11, 0x20000
  s_waitcnt lgkmcnt(0)
  s_mov_b32 s8, s40
  s_mov_b32 s9, s41
  s_or_b32 s46, s48, 1
  s_mul_i32 s46, s46, 0x9e3779b1
  s_cmp_lg_u32 s2, 0
  s_cbranch_scc1 L_helper
  v_mov_b32 v5, s46
  s_mov_b64 exec, 1
  buffer_store_dword v5, v4, s[8:11], 0 offen sc1
  s_mov_b64 exec, -1
  s_branch L_helper
L_xld:
  v_mul_u32_u24 v5, 40, v6
  s_mul_i32 s29, s5, 320
  s_mov_b32 s34, 2560
  s_mov_b32 s35, 0x20000
  buffer_load_dwordx4 v[28:31], v5, s[32:35], s29 offen offset:0
  buffer_load_dwordx4 v[32:35], v5, s[32:35], s29 offen offset:16
  buffer_load_dwordx2 v[36:37], v5, s[32:35], s29 offen offset:32
  buffer_load_dwordx4 v[38:41], v5, s[32:35], s29 offen offset:1280
  buffer_load_dwordx4 v[42:45], v5, s[32:35], s29 offen offset:1296
  buffer_load_dwordx2 v[46:47], v5, s[32:35], s29 offen offset:1312
  v_mov_b32 v4, 0
  v_and_b32 v5, 1, v7
  v_lshlrev_b32 v5, 4, v5
  v_mov_b32 v8, 0xffff
  v_lshlrev_b32 v5, v5, v8
  v_lshrrev_b32 v8, 1, v7
  v_cmp_eq_u32 vcc, 0, v8
  s_nop 1
  v_cndmask_b32 v16, 0, v5, vcc
  v_cmp_eq_u32 vcc, 1, v8
  s_nop 1
  v_cndmask_b32 v17, 0, v5, vcc
  v_cmp_eq_u32 vcc, 2, v8
  s_nop 1
  v_cndmask_b32 v18, 0, v5, vcc
  v_cmp_eq_u32 vcc, 3, v8
  s_nop 1
  v_cndmask_b32 v19, 0, v5, vcc
  s_mov_b32 s54, 0x00ff00ff
  s_mov_b32 s55, 0xff00ff00
  v_mul_u32_u24 v2, 384, v6
  v_lshl_add_u32 v2, v7, 4, v2
  s_lshl_b32 s13, s4, 2
  s_add_u32 s13, s13, s5
  s_mul_i32 s13, s13, 3072
  s_mul_i32 s47, s3, 3145728
  s_add_u32 s13, s13, s47
  s_mov_b32 s12, s13
  s_mov_b32 s8, s66
  s_mov_b32 s9, s67
  s_mov_b32 s10, 201326592
  s_mov_b32 s11, 0x20000
  s_mov_b32 s52, 0x01000100
  s_mov_b32 s53, 0x03020302
  s_waitcnt vmcnt(12)
  buffer_load_dwordx4 a[28:31], v3, s[24:27], s28 offen nt
  s_addk_i32 s28, 12288
  s_waitcnt vmcnt(12)
  buffer_load_dwordx4 a[32:35], v3, s[24:27], s28 offen nt
  s_addk_i32 s28, 12288
  s_waitcnt vmcnt(12)
  buffer_load_dwordx4 a[36:39], v3, s[24:27], s28 offen nt
  s_addk_i32 s28, 12288
  s_waitcnt vmcnt(12)
  buffer_load_dwordx4 a[40:43], v3, s[24:27], s28 offen nt
  s_addk_i32 s28, 12288
  s_waitcnt vmcnt(12)
  buffer_load_dwordx4 a[44:47], v3, s[24:27], s28 offen nt
  s_addk_i32 s28, 12288
  s_waitcnt vmcnt(12)
  buffer_load_dwordx4 a[48:51], v3, s[24:27], s28 offen nt
  s_addk_i32 s28, 12288
  s_waitcnt vmcnt(12)
  buffer_load_dwordx4 a[52:55], v3, s[24:27], s28 offen nt
  s_addk_i32 s28, 12288
  s_waitcnt vmcnt(6)
  buffer_load_dwordx4 a[56:59], v3, s[24:27], s28 offen nt
  s_addk_i32 s28, 12288
  v_perm_b32 v5, v28, v28, s52
  v_and_b32 v20, v5, v16
  v_and_b32 v21, v5, v17
  v_and_b32 v22, v5, v18
  v_and_b32 v23, v5, v19
  v_perm_b32 v5, v38, v38, s52
  v_and_b32 v24, v5, v16
  v_and_b32 v25, v5, v17
  v_and_b32 v26, v5, v18
  v_and_b32 v27, v5, v19
  v_mfma_f32_16x16x32_bf16 v[48:51], v[20:23], a[0:3], 0
  s_nop 0
  v_mfma_f32_16x16x32_bf16 v[52:55], v[24:27], a[0:3], 0
  v_perm_b32 v5, v28, v28, s53
  v_and_b32 v20, v5, v16
  v_and_b32 v21, v5, v17
  v_and_b32 v22, v5, v18
  v_and_b32 v23, v5, v19
  v_perm_b32 v5, v38, v38, s53
  v_and_b32 v24, v5, v16
  v_and_b32 v25, v5, v17
  v_and_b32 v26, v5, v18
  v_and_b32 v27, v5, v19
  v_mfma_f32_16x16x32_bf16 v[48:51], v[20:23], a[4:7], v[48:51]
  s_nop 0
  v_mfma_f32_16x16x32_bf16 v[52:55], v[24:27], a[4:7], v[52:55]
  s_waitcnt vmcnt(6)
  buffer_load_dwordx4 a[60:63], v3, s[24:27], s28 offen nt
  s_addk_i32 s28, 12288
  v_perm_b32 v5, v29, v29, s52
  v_and_b32 v20, v5, v16
  v_and_b32 v21, v5, v17
  v_and_b32 v22, v5, v18
  v_and_b32 v23, v5, v19
  v_perm_b32 v5, v39, v39, s52
  v_and_b32 v24, v5, v16
  v_and_b32 v25, v5, v17
  v_and_b32 v26, v5, v18
  v_and_b32 v27, v5, v19
  v_mfma_f32_16x16x32_bf16 v[48:51], v[20:23], a[8:11], v[48:51]
  s_nop 0
  v_mfma_f32_16x16x32_bf16 v[52:55], v[24:27], a[8:11], v[52:55]
  v_perm_b32 v5, v29, v29, s53
  v_and_b32 v20, v5, v16
  v_and_b32 v21, v5, v17
  v_and_b32 v22, v5, v18
  v_and_b32 v23, v5, v19
  v_perm_b32 v5, v39, v39, s53
  v_and_b32 v24, v5, v16
  v_and_b32 v25, v5, v17
  v_and_b32 v26, v5, v18
  v_and_b32 v27, v5, v19
  v_mfma_f32_16x16x32_bf16 v[48:51], v[20:23], a[12:15], v[48:51]
  s_nop 0
  v_mfma_f32_16x16x32_bf16 v[52:55], v[24:27], a[12:15], v[52:55]
  s_waitcnt vmcnt(6)
  buffer_load_dwordx4 a[64:67], v3, s[24:27], s28 offen nt
  s_addk_i32 s28, 12288
  v_perm_b32 v5, v30, v30, s52
  v_and_b32 v20, v5, v16
  v_and_b32 v21, v5, v17
  v_and_b32 v22, v5, v18
  v_and_b32 v23, v5, v19
  v_perm_b32 v5, v40, v40, s52
  v_and_b32 v24, v5, v16
  v_and_b32 v25, v5, v17
  v_and_b32 v26, v5, v18
  v_and_b32 v27, v5, v19
  v_mfma_f32_16x16x32_bf16 v[48:51], v[20:23], a[16:19], v[48:51]
  s_nop 0
  v_mfma_f32_16x16x32_bf16 v[52:55], v[24:27], a[16:19], v[52:55]
  v_perm_b32 v5, v30, v30, s53
  v_and_b32 v20, v5, v16
  v_and_b32 v21, v5, v17
  v_and_b32 v22, v5, v18
  v_and_b32 v23, v5, v19
  v_perm_b32 v5, v40, v40, s53
  v_and_b32 v24, v5, v16
  v_and_b32 v25, v5, v17
  v_and_b32 v26, v5, v18
  v_and_b32 v27, v5, v19
  v_mfma_f32_16x16x32_bf16 v[48:51], v[20:23], a[20:23], v[48:51]
  s_nop 0
  v_mfma_f32_16x16x32_bf16 v[52:55], v[24:27], a[20:23], v[52:55]
  s_waitcnt vmcnt(6)
  buffer_load_dwordx4 a[68:71], v3, s[24:27], s28 offen nt
  s_addk_i32 s28, 12288
  v_perm_b32 v5, v31, v31, s52
  v_and_b32 v20, v5, v16
  v_and_b32 v21, v5, v17
  v_and_b32 v22, v5, v18
  v_and_b32 v23, v5, v19
  v_perm_b32 v5, v41, v41, s52
  v_and_b32 v24, v5, v16
  v_and_b32 v25, v5, v17
  v_and_b32 v26, v5, v18
  v_and_b32 v27, v5, v19
  v_mfma_f32_16x16x32_bf16 v[48:51], v[20:23], a[24:27], v[48:51]
  s_nop 0
  v_mfma_f32_16x16x32_bf16 v[52:55], v[24:27], a[24:27], v[52:55]
  v_perm_b32 v5, v31, v31, s53
  v_and_b32 v20, v5, v16
  v_and_b32 v21, v5, v17
  v_and_b32 v22, v5, v18
  v_and_b32 v23, v5, v19
  v_perm_b32 v5, v41, v41, s53
  v_and_b32 v24, v5, v16
  v_and_b32 v25, v5, v17
  v_and_b32 v26, v5, v18
  v_and_b32 v27, v5, v19
  v_mfma_f32_16x16x32_bf16 v[48:51], v[20:23], a[28:31], v[48:51]
  s_nop 0
  v_mfma_f32_16x16x32_bf16 v[52:55], v[24:27], a[28:31], v[52:55]
  s_waitcnt vmcnt(6)
  buffer_load_dwordx4 a[72:75], v3, s[24:27], s28 offen nt
  s_addk_i32 s28, 12288
  v_perm_b32 v5, v32, v32, s52
  v_and_b32 v20, v5, v16
  v_and_b32 v21, v5, v17
  v_and_b32 v22, v5, v18
  v_and_b32 v23, v5, v19
  v_perm_b32 v5, v42, v42, s52
  v_and_b32 v24, v5, v16
  v_and_b32 v25, v5, v17
  v_and_b32 v26, v5, v18
  v_and_b32 v27, v5, v19
  v_mfma_f32_16x16x32_bf16 v[48:51], v[20:23], a[32:35], v[48:51]
  s_nop 0
  v_mfma_f32_16x16x32_bf16 v[52:55], v[24:27], a[32:35], v[52:55]
  v_perm_b32 v5, v32, v32, s53
  v_and_b32 v20, v5, v16
  v_and_b32 v21, v5, v17
  v_and_b32 v22, v5, v18
  v_and_b32 v23, v5, v19
  v_perm_b32 v5, v42, v42, s53
  v_and_b32 v24, v5, v16
  v_and_b32 v25, v5, v17
  v_and_b32 v26, v5, v18
  v_and_b32 v27, v5, v19
  v_mfma_f32_16x16x32_bf16 v[48:51], v[20:23], a[36:39], v[48:51]
  s_nop 0
  v_mfma_f32_16x16x32_bf16 v[52:55], v[24:27], a[36:39], v[52:55]
  s_waitcnt vmcnt(6)
  buffer_load_dwordx4 a[76:79], v3, s[24:27], s28 offen nt
  v_perm_b32 v5, v33, v33, s52
  v_and_b32 v20, v5, v16
  v_and_b32 v21, v5, v17
  v_and_b32 v22, v5, v18
  v_and_b32 v23, v5, v19
  v_perm_b32 v5, v43, v43, s52
  v_and_b32 v24, v5, v16
  v_and_b32 v25, v5, v17
  v_and_b32 v26, v5, v18
  v_and_b32 v27, v5, v19
  v_mfma_f32_16x16x32_bf16 v[48:51], v[20:23], a[40:43], v[48:51]
  s_nop 0
  v_mfma_f32_16x16x32_bf16 v[52:55], v[24:27], a[40:43], v[52:55]
  v_perm_b32 v5, v33, v33, s53
  v_and_b32 v20, v5, v16
  v_and_b32 v21, v5, v17
  v_and_b32 v22, v5, v18
  v_and_b32 v23, v5, v19
  v_perm_b32 v5, v43, v43, s53
  v_and_b32 v24, v5, v16
  v_and_b32 v25, v5, v17
  v_and_b32 v26, v5, v18
  v_and_b32 v27, v5, v19
  v_mfma_f32_16x16x32_bf16 v[48:51], v[20:23], a[44:47], v[48:51]
  s_nop 0
  v_mfma_f32_16x16x32_bf16 v[52:55], v[24:27], a[44:47], v[52:55]
  s_waitcnt vmcnt(6)
  v_perm_b32 v5, v34, v34, s52
  v_and_b32 v20, v5, v16
  v_and_b32 v21, v5, v17
  v_and_b32 v22, v5, v18
  v_and_b32 v23, v5, v19
  v_perm_b32 v5, v44, v44, s52
  v_and_b32 v24, v5, v16
  v_and_b32 v25, v5, v17
  v_and_b32 v26, v5, v18
  v_and_b32 v27, v5, v19
  v_mfma_f32_16x16x32_bf16 v[48:51], v[20:23], a[48:51], v[48:51]
  s_nop 0
  v_mfma_f32_16x16x32_bf16 v[52:55], v[24:27], a[48:51], v[52:55]
  v_perm_b32 v5, v34, v34, s53
  v_and_b32 v20, v5, v16
  v_and_b32 v21, v5, v17
  v_and_b32 v22, v5, v18
  v_and_b32 v23, v5, v19
  v_perm_b32 v5, v44, v44, s53
  v_and_b32 v24, v5, v16
  v_and_b32 v25, v5, v17
  v_and_b32 v26, v5, v18
  v_and_b32 v27, v5, v19
  v_mfma_f32_16x16x32_bf16 v[48:51], v[20:23], a[52:55], v[48:51]
  s_nop 0
  v_mfma_f32_16x16x32_bf16 v[52:55], v[24:27], a[52:55], v[52:55]
  s_waitcnt vmcnt(5)
  v_perm_b32 v5, v35, v35, s52
  v_and_b32 v20, v5, v16
  v_and_b32 v21, v5, v17
  v_and_b32 v22, v5, v18
  v_and_b32 v23, v5, v19
  v_perm_b32 v5, v45, v45, s52
  v_and_b32 v24, v5, v16
  v_and_b32 v25, v5, v17
  v_and_b32 v26, v5, v18
  v_and_b32 v27, v5, v19
  v_mfma_f32_16x16x32_bf16 v[48:51], v[20:23], a[56:59], v[48:51]
  s_nop 0
  v_mfma_f32_16x16x32_bf16 v[52:55], v[24:27], a[56:59], v[52:55]
  s_waitcnt vmcnt(4)
  buffer_load_dwordx4 v[60:63], v2, s[8:11], s12 offen offset:0 nt
  v_perm_b32 v5, v35, v35, s53
  v_and_b32 v20, v5, v16
  v_and_b32 v21, v5, v17
  v_and_b32 v22, v5, v18
  v_and_b32 v23, v5, v19
  v_perm_b32 v5, v45, v45, s53
  v_and_b32 v24, v5, v16
  v_and_b32 v25, v5, v17
  v_and_b32 v26, v5, v18
  v_and_b32 v27, v5, v19
  v_mfma_f32_16x16x32_bf16 v[48:51], v[20:23], a[60:63], v[48:51]
  s_nop 0
  v_mfma_f32_16x16x32_bf16 v[52:55], v[24:27], a[60:63], v[52:55]
  s_waitcnt vmcnt(4)
  buffer_load_dwordx4 v[64:67], v2, s[8:11], s12 offen offset:128 nt
  v_perm_b32 v5, v36, v36, s52
  v_and_b32 v20, v5, v16
  v_and_b32 v21, v5, v17
  v_and_b32 v22, v5, v18
  v_and_b32 v23, v5, v19
  v_perm_b32 v5, v46, v46, s52
  v_and_b32 v24, v5, v16
  v_and_b32 v25, v5, v17
  v_and_b32 v26, v5, v18
  v_and_b32 v27, v5, v19
  v_mfma_f32_16x16x32_bf16 v[48:51], v[20:23], a[64:67], v[48:51]
  s_nop 0
  v_mfma_f32_16x16x32_bf16 v[52:55], v[24:27], a[64:67], v[52:55]
  s_waitcnt vmcnt(4)
  buffer_load_dwordx4 v[68:71], v2, s[8:11], s12 offen offset:256 nt
  s_add_u32 s12, s12, 1179648
  v_perm_b32 v5, v36, v36, s53
  v_and_b32 v20, v5, v16
  v_and_b32 v21, v5, v17
  v_and_b32 v22, v5, v18
  v_and_b32 v23, v5, v19
  v_perm_b32 v5, v46, v46, s53
  v_and_b32 v24, v5, v16
  v_and_b32 v25, v5, v17
  v_and_b32 v26, v5, v18
  v_and_b32 v27, v5, v19
  v_mfma_f32_16x16x32_bf16 v[48:51], v[20:23], a[68:71], v[48:51]
  s_nop 0
  v_mfma_f32_16x16x32_bf16 v[52:55], v[24:27], a[68:71], v[52:55]
  s_waitcnt vmcnt(4)
  buffer_load_dwordx4 v[72:75], v2, s[8:11], s12 offen offset:0 nt
  v_perm_b32 v5, v37, v37, s52
  v_and_b32 v20, v5, v16
  v_and_b32 v21, v5, v17
  v_and_b32 v22, v5, v18
  v_and_b32 v23, v5, v19
  v_perm_b32 v5, v47, v47, s52
  v_and_b32 v24, v5, v16
  v_and_b32 v25, v5, v17
  v_and_b32 v26, v5, v18
  v_and_b32 v27, v5, v19
  v_mfma_f32_16x16x32_bf16 v[48:51], v[20:23], a[72:75], v[48:51]
  s_nop 0
  v_mfma_f32_16x16x32_bf16 v[52:55], v[24:27], a[72:75], v[52:55]
  s_waitcnt vmcnt(4)
  buffer_load_dwordx4 v[76:79], v2, s[8:11], s12 offen offset:128 nt
  v_perm_b32 v5, v37, v37, s53
  v_and_b32 v20, v5, v16
  v_and_b32 v21, v5, v17
  v_and_b32 v22, v5, v18
  v_and_b32 v23, v5, v19
  v_perm_b32 v5, v47, v47, s53
  v_and_b32 v24, v5, v16
  v_and_b32 v25, v5, v17
  v_and_b32 v26, v5, v18
  v_and_b32 v27, v5, v19
  v_mfma_f32_16x16x32_bf16 v[48:51], v[20:23], a[76:79], v[48:51]
  s_nop 0
  v_mfma_f32_16x16x32_bf16 v[52:55], v[24:27], a[76:79], v[52:55]
  v_lshrrev_b32 v5, 5, v1
  v_lshlrev_b32 v5, 9, v5
  v_lshl_add_u32 v5, v7, 5, v5
  v_and_b32 v8, 16, v1
  v_add_u32 v5, v5, v8
  s_lshl_b32 s47, s5, 10
  v_add_u32 v5, s47, v5
  s_nop 0
  s_mov_b64 exec, s[54:55]
  ds_write_b128 v5, v[48:51] offset:16896
  ds_write_b128 v5, v[52:55] offset:17152
  s_mov_b64 exec, -1
  s_waitcnt lgkmcnt(0)
  s_barrier
  s_branch L_qdone
L_noq:
  v_mul_u32_u24 v2, 384, v6
  v_lshl_add_u32 v2, v7, 4, v2
  s_lshl_b32 s13, s4, 2
  s_add_u32 s13, s13, s5
  s_mul_i32 s13, s13, 3072
  s_mul_i32 s47, s3, 3145728
  s_add_u32 s13, s13, s47
  s_mov_b32 s12, s13
  s_mov_b32 s8, s66
  s_mov_b32 s9, s67
  s_mov_b32 s10, 201326592
  s_mov_b32 s11, 0x20000
  buffer_load_dwordx4 v[60:63], v2, s[8:11], s12 offen offset:0 nt
  buffer_load_dwordx4 v[64:67], v2, s[8:11], s12 offen offset:128 nt
  buffer_load_dwordx4 v[68:71], v2, s[8:11], s12 offen offset:256 nt
  s_add_u32 s12, s12, 1179648
  buffer_load_dwordx4 v[72:75], v2, s[8:11], s12 offen offset:0 nt
  v_mov_b32 v4, 0
  v_and_b32 v5, 1, v7
  v_lshlrev_b32 v5, 4, v5
  v_mov_b32 v8, 0xffff
  v_lshlrev_b32 v5, v5, v8
  v_lshrrev_b32 v8, 1, v7
  v_cmp_eq_u32 vcc, 0, v8
  s_nop 1
  v_cndmask_b32 v16, 0, v5, vcc
  v_cmp_eq_u32 vcc, 1, v8
  s_nop 1
  v_cndmask_b32 v17, 0, v5, vcc
  v_cmp_eq_u32 vcc, 2, v8
  s_nop 1
  v_cndmask_b32 v18, 0, v5, vcc
  v_cmp_eq_u32 vcc, 3, v8
  s_nop 1
  v_cndmask_b32 v19, 0, v5, vcc
  s_mov_b32 s54, 0x00ff00ff
  s_mov_b32 s55, 0xff00ff00
  s_waitcnt vmcnt(3)
  buffer_load_dwordx4 v[76:79], v2, s[8:11], s12 offen offset:128 nt
L_qdone:
  s_cmp_ge_u32 s4, 24
  s_cselect_b64 vcc, -1, 0
  s_cmp_ge_u32 s4, 28
  s_cselect_b64 vcc, 0, vcc
  s_waitcnt vmcnt(4)
  s_cbranch_vccz L_rf5
  s_waitcnt vmcnt(3)
L_rf5:
  buffer_load_dwordx4 v[80:83], v2, s[8:11], s12 offen offset:256 nt
  s_add_u32 s12, s12, 1179648
  s_mul_i32 s47, s5, 2176
  s_add_u32 s47, s47, 8128
  v_mul_u32_u24 v9, 272, v6
  v_add_u32 v9, s47, v9
  s_waitcnt vmcnt(4)
  s_cbranch_vccz L_rf6
  s_waitcnt vmcnt(3)
L_rf6:
  buffer_load_dwordx4 v[84:87], v2, s[8:11], s12 offen offset:0 nt
  v_lshlrev_b32 v10, 4, v7
  s_lshl_b32 s47, s5, 3
  v_mov_b32 v12, s47
  s_lshl_b32 s47, s5, 2
  v_mov_b32 v13, s47
  v_mov_b32 v14, 0
  s_waitcnt vmcnt(4)
  s_cbranch_vccz L_rf7
  s_waitcnt vmcnt(3)
L_rf7:
  buffer_load_dwordx4 v[88:91], v2, s[8:11], s12 offen offset:128 nt
  v_lshrrev_b32 v11, 5, v1
  v_mul_u32_u24 v11, 768, v11
  v_lshl_add_u32 v11, v7, 5, v11
  v_and_b32 v8, 16, v1
  v_add_u32 v11, v11, v8
  s_mul_i32 s47, s5, 1536
  s_add_u32 s47, s47, 20992
  v_add_u32 v11, s47, v11
  s_waitcnt vmcnt(4)
  s_cbranch_vccz L_rf8
  s_waitcnt vmcnt(3)
L_rf8:
  buffer_load_dwordx4 v[92:95], v2, s[8:11], s12 offen offset:256 nt
  s_sub_u32 s12, s12, 1966080
  s_mov_b32 s16, s68
  s_mov_b32 s17, s69
  s_mov_b32 s18, s76
  s_mov_b32 s19, s77
  s_mov_b32 s20, s78
  s_mov_b32 s21, s79
  s_waitcnt vmcnt(4)
  s_cbranch_vccz L_rf9
  s_waitcnt vmcnt(3)
L_rf9:
  buffer_load_dwordx4 v[96:99], v2, s[8:11], s12 offen offset:0 nt
  s_cmp_ge_u32 s4, 16
  s_cselect_b32 s24, s82, s72
  s_cselect_b32 s25, s83, s73
  s_lshr_b32 s47, s4, 2
  s_and_b32 s47, s47, 3
  s_lshl_b32 s47, s47, 3
  s_add_u32 s47, s47, s3
  s_mul_i32 s47, s47, 12
  s_and_b32 s48, s4, 3
  s_add_u32 s47, s47, s48
  s_mul_i32 s47, s47, 20480
  s_lshl_b32 s48, s5, 8
  s_add_u32 s28, s47, s48
  v_lshrrev_b32 v3, 4, v1
  v_mul_u32_u24 v3, 1280, v3
  v_and_b32 v8, 15, v1
  v_lshl_add_u32 v3, v8, 4, v3
  s_waitcnt vmcnt(4)
  s_cbranch_vccz L_rf10
  s_waitcnt vmcnt(3)
L_rf10:
  buffer_load_dwordx4 v[100:103], v2, s[8:11], s12 offen offset:128 nt
  s_mov_b32 s36, s42
  s_mov_b32 s37, s43
  s_mov_b32 s38, 836768768
  s_mov_b32 s39, 0x20000
  s_mov_b32 s14, 0
  s_mov_b32 s15, 0x20000
  s_waitcnt vmcnt(4)
  s_cbranch_vccz L_rf11
  s_waitcnt vmcnt(3)
L_rf11:
  buffer_load_dwordx4 v[104:107], v2, s[8:11], s12 offen offset:256 nt
  s_add_u32 s12, s12, 1179648
  s_mov_b32 s58, 0x3dd53b95
  s_mov_b32 s44, 0
  s_mov_b32 s45, 16
  s_mov_b32 s30, 0
  s_waitcnt vmcnt(4)
  s_cbranch_vccz L_rf12
  s_waitcnt vmcnt(3)
L_rf12:
  buffer_load_dwordx4 v[108:111], v2, s[8:11], s12 offen offset:0 nt
  s_waitcnt vmcnt(4)
  s_cbranch_vccz L_rf13
  s_waitcnt vmcnt(3)
L_rf13:
  buffer_load_dwordx4 v[112:115], v2, s[8:11], s12 offen offset:128 nt
  s_waitcnt vmcnt(4)
  s_cbranch_vccz L_rf14
  s_waitcnt vmcnt(3)
L_rf14:
  buffer_load_dwordx4 v[116:119], v2, s[8:11], s12 offen offset:256 nt
  s_add_u32 s12, s12, 1179648
  s_waitcnt vmcnt(4)
  s_cbranch_vccz L_rf15
  s_waitcnt vmcnt(3)
L_rf15:
  buffer_load_dwordx4 v[120:123], v2, s[8:11], s12 offen offset:0 nt
  s_waitcnt vmcnt(4)
  s_cbranch_vccz L_rf16
  s_waitcnt vmcnt(3)
L_rf16:
  buffer_load_dwordx4 v[124:127], v2, s[8:11], s12 offen offset:128 nt
  s_waitcnt vmcnt(4)
  s_cbranch_vccz L_rf17
  s_waitcnt vmcnt(3)
L_rf17:
  buffer_load_dwordx4 v[128:131], v2, s[8:11], s12 offen offset:256 nt
  s_sub_u32 s12, s12, 1966080
  s_waitcnt vmcnt(4)
  s_cbranch_vccz L_rf18
  s_waitcnt vmcnt(3)
L_rf18:
  buffer_load_dwordx4 v[132:135], v2, s[8:11], s12 offen offset:0 nt
  s_waitcnt vmcnt(4)
  s_cbranch_vccz L_rf19
  s_waitcnt vmcnt(3)
L_rf19:
  buffer_load_dwordx4 v[136:139], v2, s[8:11], s12 offen offset:128 nt
  s_waitcnt vmcnt(4)
  s_cbranch_vccz L_rf20
  s_waitcnt vmcnt(3)
L_rf20:
  buffer_load_dwordx4 v[140:143], v2, s[8:11], s12 offen offset:256 nt
  s_add_u32 s12, s12, 1179648
  s_waitcnt vmcnt(4)
  s_cbranch_vccz L_rf21
  s_waitcnt vmcnt(3)
L_rf21:
  buffer_load_dwordx4 v[144:147], v2, s[8:11], s12 offen offset:0 nt
  s_waitcnt vmcnt(4)
  s_cbranch_vccz L_rf22
  s_waitcnt vmcnt(3)
L_rf22:
  buffer_load_dwordx4 v[148:151], v2, s[8:11], s12 offen offset:128 nt
  s_waitcnt vmcnt(4)
  s_cbranch_vccz L_rf23
  s_waitcnt vmcnt(3)
L_rf23:
  buffer_load_dwordx4 v[152:155], v2, s[8:11], s12 offen offset:256 nt
  s_cmp_lt_u32 s4, 28
  s_cbranch_scc1 L_noearly
  s_waitcnt vmcnt(4)
  buffer_load_dwordx4 a[0:3], v3, s[24:27], s28 offen nt
  s_addk_i32 s28, 5120
  s_waitcnt vmcnt(4)
  buffer_load_dwordx4 a[4:7], v3, s[24:27], s28 offen nt
  s_addk_i32 s28, 5120
  s_waitcnt vmcnt(4)
  buffer_load_dwordx4 a[8:11], v3, s[24:27], s28 offen nt
  s_addk_i32 s28, 5120
  s_waitcnt vmcnt(4)
  buffer_load_dwordx4 a[12:15], v3, s[24:27], s28 offen nt
  s_add_u32 s28, s28, 66560
  s_waitcnt vmcnt(4)
  buffer_load_dwordx4 a[16:19], v3, s[24:27], s28 offen nt
  s_addk_i32 s28, 5120
  s_waitcnt vmcnt(4)
  buffer_load_dwordx4 a[20:23], v3, s[24:27], s28 offen nt
  s_addk_i32 s28, 5120
  s_waitcnt vmcnt(4)
  buffer_load_dwordx4 a[24:27], v3, s[24:27], s28 offen nt
  s_addk_i32 s28, 5120
  s_waitcnt vmcnt(4)
  buffer_load_dwordx4 a[28:31], v3, s[24:27], s28 offen nt
  s_add_u32 s28, s28, 66560
  s_waitcnt vmcnt(4)
  buffer_load_dwordx4 a[32:35], v3, s[24:27], s28 offen nt
  s_addk_i32 s28, 5120
  s_waitcnt vmcnt(4)
  buffer_load_dwordx4 a[36:39], v3, s[24:27], s28 offen nt
  s_addk_i32 s28, 5120
  s_waitcnt vmcnt(4)
  buffer_load_dwordx4 a[40:43], v3, s[24:27], s28 offen nt
  s_addk_i32 s28, 5120
  s_waitcnt vmcnt(4)
  buffer_load_dwordx4 a[44:47], v3, s[24:27], s28 offen nt
L_noearly:
  s_barrier
  ds_read_b128 v[28:31], v10 offset:1600
  ds_read_b128 v[32:35], v10 offset:1728
  ds_read_b128 v[36:39], v10 offset:1856
  s_waitcnt lgkmcnt(0)
L_kloop:
  s_add_u32 s47, s44, 1
  s_and_b32 s47, s47, 7
  s_cbranch_scc1 L_ksw
  s_mov_b32 s8, s16
  s_mov_b32 s9, s17
  s_mov_b32 s16, s18
  s_mov_b32 s17, s19
  s_mov_b32 s18, s20
  s_mov_b32 s19, s21
L_ksw:
  s_mul_i32 s47, s47, 25165824
  s_add_u32 s12, s13, s47
  s_waitcnt vmcnt(21)
  v_dot2_f32_bf16 v40, v60, v28, 0
  v_dot2_f32_bf16 v40, v61, v29, v40
  v_dot2_f32_bf16 v40, v62, v30, v40
  v_dot2_f32_bf16 v40, v63, v31, v40
  v_dot2_f32_bf16 v40, v64, v32, v40
  v_dot2_f32_bf16 v40, v65, v33, v40
  v_dot2_f32_bf16 v40, v66, v34, v40
  v_dot2_f32_bf16 v40, v67, v35, v40
  v_dot2_f32_bf16 v40, v68, v36, v40
  v_dot2_f32_bf16 v40, v69, v37, v40
  v_dot2_f32_bf16 v40, v70, v38, v40
  v_dot2_f32_bf16 v40, v71, v39, v40
  s_waitcnt vmcnt(7)
  s_cmpk_gt_i32 s45, 0x12c
  s_cbranch_scc1 L_k_0
  s_waitcnt vmcnt(6)
  s_cmpk_gt_i32 s45, 0x78
  s_cbranch_scc1 L_k_0
  s_waitcnt vmcnt(5)
  s_cmpk_gt_i32 s45, 0xf
  s_cbranch_scc1 L_k_0
  s_waitcnt vmcnt(4)
  s_cmpk_gt_i32 s45, 0xff38
  s_cbranch_scc1 L_k_0
  s_waitcnt vmcnt(3)
L_k_0:
  buffer_load_dwordx4 v[60:63], v2, s[8:11], s12 offen offset:0 nt
  s_waitcnt vmcnt(19)
  v_dot2_f32_bf16 v41, v72, v28, 0
  v_dot2_f32_bf16 v41, v73, v29, v41
  v_dot2_f32_bf16 v41, v74, v30, v41
  v_dot2_f32_bf16 v41, v75, v31, v41
  v_dot2_f32_bf16 v41, v76, v32, v41
  v_dot2_f32_bf16 v41, v77, v33, v41
  v_dot2_f32_bf16 v41, v78, v34, v41
  v_dot2_f32_bf16 v41, v79, v35, v41
  v_dot2_f32_bf16 v41, v80, v36, v41
  v_dot2_f32_bf16 v41, v81, v37, v41
  v_dot2_f32_bf16 v41, v82, v38, v41
  v_dot2_f32_bf16 v41, v83, v39, v41
  s_waitcnt vmcnt(7)
  s_cmpk_gt_i32 s45, 0x12c
  s_cbranch_scc1 L_k_1
  s_waitcnt vmcnt(6)
  s_cmpk_gt_i32 s45, 0x78
  s_cbranch_scc1 L_k_1
  s_waitcnt vmcnt(5)
  s_cmpk_gt_i32 s45, 0xf
  s_cbranch_scc1 L_k_1
  s_waitcnt vmcnt(4)
  s_cmpk_gt_i32 s45, 0xff38
  s_cbranch_scc1 L_k_1
  s_waitcnt vmcnt(3)
L_k_1:
  buffer_load_dwordx4 v[64:67], v2, s[8:11], s12 offen offset:128 nt
  ds_read_b32 v15, v4 offset:32
  s_memrealtime s[56:57]
  s_nop 0
  v_add_f32_dpp v40, v40, v40 quad_perm:[1,0,3,2] row_mask:0xf bank_mask:0xf
  v_add_f32_dpp v41, v41, v41 quad_perm:[1,0,3,2] row_mask:0xf bank_mask:0xf
  s_nop 0
  v_add_f32_dpp v40, v40, v40 quad_perm:[2,3,0,1] row_mask:0xf bank_mask:0xf
  v_add_f32_dpp v41, v41, v41 quad_perm:[2,3,0,1] row_mask:0xf bank_mask:0xf
  s_nop 0
  v_add_f32_dpp v40, v40, v40 row_half_mirror row_mask:0xf bank_mask:0xf
  v_add_f32_dpp v41, v41, v41 row_half_mirror row_mask:0xf bank_mask:0xf
  s_waitcnt lgkmcnt(0)
  v_readfirstlane_b32 s31, v15
  s_mul_i32 s56, s56, 205
  s_lshr_b32 s56, s56, 6
  s_sub_u32 s56, s56, s30
  s_addk_i32 s30, 128
  s_add_u32 s56, s56, s31
  s_sext_i32_i16 s56, s56
  s_bitcmp0_b32 s31, 31
  s_cselect_b32 s45, s56, s45
  s_waitcnt vmcnt(7)
  s_cmpk_gt_i32 s45, 0x12c
  s_cbranch_scc1 L_k_2
  s_waitcnt vmcnt(6)
  s_cmpk_gt_i32 s45, 0x78
  s_cbranch_scc1 L_k_2
  s_waitcnt vmcnt(5)
  s_cmpk_gt_i32 s45, 0xf
  s_cbranch_scc1 L_k_2
  s_waitcnt vmcnt(4)
  s_cmpk_gt_i32 s45, 0xff38
  s_cbranch_scc1 L_k_2
  s_waitcnt vmcnt(3)
L_k_2:
  buffer_load_dwordx4 v[68:71], v2, s[8:11], s12 offen offset:256 nt
  s_add_u32 s12, s12, 1179648
  v_add_u32 v14, 1, v14
  ds_write_b32 v13, v14 offset:16
  s_waitcnt vmcnt(18)
  v_dot2_f32_bf16 v42, v84, v28, 0
  v_dot2_f32_bf16 v42, v85, v29, v42
  v_dot2_f32_bf16 v42, v86, v30, v42
  v_dot2_f32_bf16 v42, v87, v31, v42
  v_dot2_f32_bf16 v42, v88, v32, v42
  v_dot2_f32_bf16 v42, v89, v33, v42
  v_dot2_f32_bf16 v42, v90, v34, v42
  v_dot2_f32_bf16 v42, v91, v35, v42
  v_dot2_f32_bf16 v42, v92, v36, v42
  v_dot2_f32_bf16 v42, v93, v37, v42
  v_dot2_f32_bf16 v42, v94, v38, v42
  v_dot2_f32_bf16 v42, v95, v39, v42
  s_waitcnt vmcnt(7)
  s_cmpk_gt_i32 s45, 0x12c
  s_cbranch_scc1 L_k_3
  s_waitcnt vmcnt(6)
  s_cmpk_gt_i32 s45, 0x78
  s_cbranch_scc1 L_k_3
  s_waitcnt vmcnt(5)
  s_cmpk_gt_i32 s45, 0xf
  s_cbranch_scc1 L_k_3
  s_waitcnt vmcnt(4)
  s_cmpk_gt_i32 s45, 0xff38
  s_cbranch_scc1 L_k_3
  s_waitcnt vmcnt(3)
L_k_3:
  buffer_load_dwordx4 v[72:75], v2, s[8:11], s12 offen offset:0 nt
  s_waitcnt vmcnt(16)
  v_dot2_f32_bf16 v43, v96, v28, 0
  v_dot2_f32_bf16 v43, v97, v29, v43
  v_dot2_f32_bf16 v43, v98, v30, v43
  v_dot2_f32_bf16 v43, v99, v31, v43
  v_dot2_f32_bf16 v43, v100, v32, v43
  v_dot2_f32_bf16 v43, v101, v33, v43
  v_dot2_f32_bf16 v43, v102, v34, v43
  v_dot2_f32_bf16 v43, v103, v35, v43
  v_dot2_f32_bf16 v43, v104, v36, v43
  v_dot2_f32_bf16 v43, v105, v37, v43
  v_dot2_f32_bf16 v43, v106, v38, v43
  v_dot2_f32_bf16 v43, v107, v39, v43
  s_waitcnt vmcnt(7)
  s_cmpk_gt_i32 s45, 0x12c
  s_cbranch_scc1 L_k_4
  s_waitcnt vmcnt(6)
  s_cmpk_gt_i32 s45, 0x78
  s_cbranch_scc1 L_k_4
  s_waitcnt vmcnt(5)
  s_cmpk_gt_i32 s45, 0xf
  s_cbranch_scc1 L_k_4
  s_waitcnt vmcnt(4)
  s_cmpk_gt_i32 s45, 0xff38
  s_cbranch_scc1 L_k_4
  s_waitcnt vmcnt(3)
L_k_4:
  buffer_load_dwordx4 v[76:79], v2, s[8:11], s12 offen offset:128 nt
  ds_read_b32 v15, v4 offset:32
  s_memrealtime s[56:57]
  s_nop 0
  v_add_f32_dpp v42, v42, v42 quad_perm:[1,0,3,2] row_mask:0xf bank_mask:0xf
  v_add_f32_dpp v43, v43, v43 quad_perm:[1,0,3,2] row_mask:0xf bank_mask:0xf
  s_nop 0
  v_add_f32_dpp v42, v42, v42 quad_perm:[2,3,0,1] row_mask:0xf bank_mask:0xf
  v_add_f32_dpp v43, v43, v43 quad_perm:[2,3,0,1] row_mask:0xf bank_mask:0xf
  s_nop 0
  v_add_f32_dpp v42, v42, v42 row_half_mirror row_mask:0xf bank_mask:0xf
  v_add_f32_dpp v43, v43, v43 row_half_mirror row_mask:0xf bank_mask:0xf
  s_waitcnt lgkmcnt(0)
  v_readfirstlane_b32 s31, v15
  s_mul_i32 s56, s56, 205
  s_lshr_b32 s56, s56, 6
  s_sub_u32 s56, s56, s30
  s_addk_i32 s30, 128
  s_add_u32 s56, s56, s31
  s_sext_i32_i16 s56, s56
  s_bitcmp0_b32 s31, 31
  s_cselect_b32 s45, s56, s45
  s_waitcnt vmcnt(7)
  s_cmpk_gt_i32 s45, 0x12c
  s_cbranch_scc1 L_k_5
  s_waitcnt vmcnt(6)
  s_cmpk_gt_i32 s45, 0x78
  s_cbranch_scc1 L_k_5
  s_waitcnt vmcnt(5)
  s_cmpk_gt_i32 s45, 0xf
  s_cbranch_scc1 L_k_5
  s_waitcnt vmcnt(4)
  s_cmpk_gt_i32 s45, 0xff38
  s_cbranch_scc1 L_k_5
  s_waitcnt vmcnt(3)
L_k_5:
  buffer_load_dwordx4 v[80:83], v2, s[8:11], s12 offen offset:256 nt
  s_add_u32 s12, s12, 1179648
  v_add_u32 v14, 1, v14
  ds_write_b32 v13, v14 offset:16
  s_waitcnt vmcnt(15)
  v_dot2_f32_bf16 v44, v108, v28, 0
  v_dot2_f32_bf16 v44, v109, v29, v44
  v_dot2_f32_bf16 v44, v110, v30, v44
  v_dot2_f32_bf16 v44, v111, v31, v44
  v_dot2_f32_bf16 v44, v112, v32, v44
  v_dot2_f32_bf16 v44, v113, v33, v44
  v_dot2_f32_bf16 v44, v114, v34, v44
  v_dot2_f32_bf16 v44, v115, v35, v44
  v_dot2_f32_bf16 v44, v116, v36, v44
  v_dot2_f32_bf16 v44, v117, v37, v44
  v_dot2_f32_bf16 v44, v118, v38, v44
  v_dot2_f32_bf16 v44, v119, v39, v44
  s_waitcnt vmcnt(7)
  s_cmpk_gt_i32 s45, 0x12c
  s_cbranch_scc1 L_k_6
  s_waitcnt vmcnt(6)
  s_cmpk_gt_i32 s45, 0x78
  s_cbranch_scc1 L_k_6
  s_waitcnt vmcnt(5)
  s_cmpk_gt_i32 s45, 0xf
  s_cbranch_scc1 L_k_6
  s_waitcnt vmcnt(4)
  s_cmpk_gt_i32 s45, 0xff38
  s_cbranch_scc1 L_k_6
  s_waitcnt vmcnt(3)
L_k_6:
  buffer_load_dwordx4 v[84:87], v2, s[8:11], s12 offen offset:0 nt
  s_waitcnt vmcnt(13)
  v_dot2_f32_bf16 v45, v120, v28, 0
  v_dot2_f32_bf16 v45, v121, v29, v45
  v_dot2_f32_bf16 v45, v122, v30, v45
  v_dot2_f32_bf16 v45, v123, v31, v45
  v_dot2_f32_bf16 v45, v124, v32, v45
  v_dot2_f32_bf16 v45, v125, v33, v45
  v_dot2_f32_bf16 v45, v126, v34, v45
  v_dot2_f32_bf16 v45, v127, v35, v45
  v_dot2_f32_bf16 v45, v128, v36, v45
  v_dot2_f32_bf16 v45, v129, v37, v45
  v_dot2_f32_bf16 v45, v130, v38, v45
  v_dot2_f32_bf16 v45, v131, v39, v45
  s_waitcnt vmcnt(7)
  s_cmpk_gt_i32 s45, 0x12c
  s_cbranch_scc1 L_k_7
  s_waitcnt vmcnt(6)
  s_cmpk_gt_i32 s45, 0x78
  s_cbranch_scc1 L_k_7
  s_waitcnt vmcnt(5)
  s_cmpk_gt_i32 s45, 0xf
  s_cbranch_scc1 L_k_7
  s_waitcnt vmcnt(4)
  s_cmpk_gt_i32 s45, 0xff38
  s_cbranch_scc1 L_k_7
  s_waitcnt vmcnt(3)
L_k_7:
  buffer_load_dwordx4 v[88:91], v2, s[8:11], s12 offen offset:128 nt
  ds_read_b32 v15, v4 offset:32
  s_memrealtime s[56:57]
  s_nop 0
  v_add_f32_dpp v44, v44, v44 quad_perm:[1,0,3,2] row_mask:0xf bank_mask:0xf
  v_add_f32_dpp v45, v45, v45 quad_perm:[1,0,3,2] row_mask:0xf bank_mask:0xf
  s_nop 0
  v_add_f32_dpp v44, v44, v44 quad_perm:[2,3,0,1] row_mask:0xf bank_mask:0xf
  v_add_f32_dpp v45, v45, v45 quad_perm:[2,3,0,1] row_mask:0xf bank_mask:0xf
  s_nop 0
  v_add_f32_dpp v44, v44, v44 row_half_mirror row_mask:0xf bank_mask:0xf
  v_add_f32_dpp v45, v45, v45 row_half_mirror row_mask:0xf bank_mask:0xf
  s_waitcnt lgkmcnt(0)
  v_readfirstlane_b32 s31, v15
  s_mul_i32 s56, s56, 205
  s_lshr_b32 s56, s56, 6
  s_sub_u32 s56, s56, s30
  s_addk_i32 s30, 128
  s_add_u32 s56, s56, s31
  s_sext_i32_i16 s56, s56
  s_bitcmp0_b32 s31, 31
  s_cselect_b32 s45, s56, s45
  s_waitcnt vmcnt(7)
  s_cmpk_gt_i32 s45, 0x12c
  s_cbranch_scc1 L_k_8
  s_waitcnt vmcnt(6)
  s_cmpk_gt_i32 s45, 0x78
  s_cbranch_scc1 L_k_8
  s_waitcnt vmcnt(5)
  s_cmpk_gt_i32 s45, 0xf
  s_cbranch_scc1 L_k_8
  s_waitcnt vmcnt(4)
  s_cmpk_gt_i32 s45, 0xff38
  s_cbranch_scc1 L_k_8
  s_waitcnt vmcnt(3)
L_k_8:
  buffer_load_dwordx4 v[92:95], v2, s[8:11], s12 offen offset:256 nt
  s_sub_u32 s12, s12, 1966080
  v_add_u32 v14, 1, v14
  ds_write_b32 v13, v14 offset:16
  s_waitcnt vmcnt(12)
  v_dot2_f32_bf16 v46, v132, v28, 0
  v_dot2_f32_bf16 v46, v133, v29, v46
  v_dot2_f32_bf16 v46, v134, v30, v46
  v_dot2_f32_bf16 v46, v135, v31, v46
  v_dot2_f32_bf16 v46, v136, v32, v46
  v_dot2_f32_bf16 v46, v137, v33, v46
  v_dot2_f32_bf16 v46, v138, v34, v46
  v_dot2_f32_bf16 v46, v139, v35, v46
  v_dot2_f32_bf16 v46, v140, v36, v46
  v_dot2_f32_bf16 v46, v141, v37, v46
  v_dot2_f32_bf16 v46, v142, v38, v46
  v_dot2_f32_bf16 v46, v143, v39, v46
  s_waitcnt vmcnt(7)
  s_cmpk_gt_i32 s45, 0x12c
  s_cbranch_scc1 L_k_9
  s_waitcnt vmcnt(6)
  s_cmpk_gt_i32 s45, 0x78
  s_cbranch_scc1 L_k_9
  s_waitcnt vmcnt(5)
  s_cmpk_gt_i32 s45, 0xf
  s_cbranch_scc1 L_k_9
  s_waitcnt vmcnt(4)
  s_cmpk_gt_i32 s45, 0xff38
  s_cbranch_scc1 L_k_9
  s_waitcnt vmcnt(3)
L_k_9:
  buffer_load_dwordx4 v[96:99], v2, s[8:11], s12 offen offset:0 nt
  s_waitcnt vmcnt(10)
  v_dot2_f32_bf16 v47, v144, v28, 0
  v_dot2_f32_bf16 v47, v145, v29, v47
  v_dot2_f32_bf16 v47, v146, v30, v47
  v_dot2_f32_bf16 v47, v147, v31, v47
  v_dot2_f32_bf16 v47, v148, v32, v47
  v_dot2_f32_bf16 v47, v149, v33, v47
  v_dot2_f32_bf16 v47, v150, v34, v47
  v_dot2_f32_bf16 v47, v151, v35, v47
  v_dot2_f32_bf16 v47, v152, v36, v47
  v_dot2_f32_bf16 v47, v153, v37, v47
  v_dot2_f32_bf16 v47, v154, v38, v47
  v_dot2_f32_bf16 v47, v155, v39, v47
  s_waitcnt vmcnt(7)
  s_cmpk_gt_i32 s45, 0x12c
  s_cbranch_scc1 L_k_10
  s_waitcnt vmcnt(6)
  s_cmpk_gt_i32 s45, 0x78
  s_cbranch_scc1 L_k_10
  s_waitcnt vmcnt(5)
  s_cmpk_gt_i32 s45, 0xf
  s_cbranch_scc1 L_k_10
  s_waitcnt vmcnt(4)
  s_cmpk_gt_i32 s45, 0xff38
  s_cbranch_scc1 L_k_10
  s_waitcnt vmcnt(3)
L_k_10:
  buffer_load_dwordx4 v[100:103], v2, s[8:11], s12 offen offset:128 nt
  ds_read_b32 v15, v4 offset:32
  s_memrealtime s[56:57]
  s_nop 0
  v_add_f32_dpp v46, v46, v46 quad_perm:[1,0,3,2] row_mask:0xf bank_mask:0xf
  v_add_f32_dpp v47, v47, v47 quad_perm:[1,0,3,2] row_mask:0xf bank_mask:0xf
  s_nop 0
  v_add_f32_dpp v46, v46, v46 quad_perm:[2,3,0,1] row_mask:0xf bank_mask:0xf
  v_add_f32_dpp v47, v47, v47 quad_perm:[2,3,0,1] row_mask:0xf bank_mask:0xf
  s_nop 0
  v_add_f32_dpp v46, v46, v46 row_half_mirror row_mask:0xf bank_mask:0xf
  v_add_f32_dpp v47, v47, v47 row_half_mirror row_mask:0xf bank_mask:0xf
  s_waitcnt lgkmcnt(0)
  v_readfirstlane_b32 s31, v15
  s_mul_i32 s56, s56, 205
  s_lshr_b32 s56, s56, 6
  s_sub_u32 s56, s56, s30
  s_addk_i32 s30, 128
  s_add_u32 s56, s56, s31
  s_sext_i32_i16 s56, s56
  s_bitcmp0_b32 s31, 31
  s_cselect_b32 s45, s56, s45
  s_waitcnt vmcnt(7)
  s_cmpk_gt_i32 s45, 0x12c
  s_cbranch_scc1 L_k_11
  s_waitcnt vmcnt(6)
  s_cmpk_gt_i32 s45, 0x78
  s_cbranch_scc1 L_k_11
  s_waitcnt vmcnt(5)
  s_cmpk_gt_i32 s45, 0xf
  s_cbranch_scc1 L_k_11
  s_waitcnt vmcnt(4)
  s_cmpk_gt_i32 s45, 0xff38
  s_cbranch_scc1 L_k_11
  s_waitcnt vmcnt(3)
L_k_11:
  buffer_load_dwordx4 v[104:107], v2, s[8:11], s12 offen offset:256 nt
  s_add_u32 s12, s12, 1179648
  v_add_u32 v14, 1, v14
  ds_write_b32 v13, v14 offset:16
  v_add_u32 v10, 384, v10
  v_max3_f32 v5, v40, v41, v42
  v_max3_f32 v5, v5, v43, v44
  v_max3_f32 v5, v5, v45, v46
  v_max_f32 v5, v5, v47
  ds_read_b128 v[28:31], v10 offset:1600
  ds_read_b128 v[32:35], v10 offset:1728
  ds_read_b128 v[36:39], v10 offset:1856
  s_waitcnt vmcnt(7)
  s_cmpk_gt_i32 s45, 0x12c
  s_cbranch_scc1 L_k_12
  s_waitcnt vmcnt(6)
  s_cmpk_gt_i32 s45, 0x78
  s_cbranch_scc1 L_k_12
  s_waitcnt vmcnt(5)
  s_cmpk_gt_i32 s45, 0xf
  s_cbranch_scc1 L_k_12
  s_waitcnt vmcnt(4)
  s_cmpk_gt_i32 s45, 0xff38
  s_cbranch_scc1 L_k_12
  s_waitcnt vmcnt(3)
L_k_12:
  buffer_load_dwordx4 v[108:111], v2, s[8:11], s12 offen offset:0 nt
  s_nop 1
  v_max_f32_dpp v5, v5, v5 row_ror:8 row_mask:0xf bank_mask:0xf
  v_mov_b32 v6, v5
  s_nop 1
  v_permlane16_swap_b32 v5, v6
  s_nop 0
  v_max_f32 v5, v5, v6
  v_mov_b32 v6, v5
  s_nop 1
  v_permlane32_swap_b32 v5, v6
  s_nop 0
  v_max_f32 v5, v5, v6
  v_mul_f32 v48, s58, v5
  s_waitcnt vmcnt(7)
  s_cmpk_gt_i32 s45, 0x12c
  s_cbranch_scc1 L_k_13
  s_waitcnt vmcnt(6)
  s_cmpk_gt_i32 s45, 0x78
  s_cbranch_scc1 L_k_13
  s_waitcnt vmcnt(5)
  s_cmpk_gt_i32 s45, 0xf
  s_cbranch_scc1 L_k_13
  s_waitcnt vmcnt(4)
  s_cmpk_gt_i32 s45, 0xff38
  s_cbranch_scc1 L_k_13
  s_waitcnt vmcnt(3)
L_k_13:
  buffer_load_dwordx4 v[112:115], v2, s[8:11], s12 offen offset:128 nt
  ds_read_b32 v15, v4 offset:32
  s_memrealtime s[56:57]
  v_fma_f32 v40, v40, s58, -v48
  v_fma_f32 v41, v41, s58, -v48
  v_fma_f32 v42, v42, s58, -v48
  v_fma_f32 v43, v43, s58, -v48
  v_fma_f32 v44, v44, s58, -v48
  v_fma_f32 v45, v45, s58, -v48
  v_fma_f32 v46, v46, s58, -v48
  v_fma_f32 v47, v47, s58, -v48
  s_waitcnt lgkmcnt(0)
  v_readfirstlane_b32 s31, v15
  s_mul_i32 s56, s56, 205
  s_lshr_b32 s56, s56, 6
  s_sub_u32 s56, s56, s30
  s_addk_i32 s30, 128
  s_add_u32 s56, s56, s31
  s_sext_i32_i16 s56, s56
  s_bitcmp0_b32 s31, 31
  s_cselect_b32 s45, s56, s45
  s_waitcnt vmcnt(7)
  s_cmpk_gt_i32 s45, 0x12c
  s_cbranch_scc1 L_k_14
  s_waitcnt vmcnt(6)
  s_cmpk_gt_i32 s45, 0x78
  s_cbranch_scc1 L_k_14
  s_waitcnt vmcnt(5)
  s_cmpk_gt_i32 s45, 0xf
  s_cbranch_scc1 L_k_14
  s_waitcnt vmcnt(4)
  s_cmpk_gt_i32 s45, 0xff38
  s_cbranch_scc1 L_k_14
  s_waitcnt vmcnt(3)
L_k_14:
  buffer_load_dwordx4 v[116:119], v2, s[8:11], s12 offen offset:256 nt
  s_add_u32 s12, s12, 1179648
  v_add_u32 v14, 1, v14
  ds_write_b32 v13, v14 offset:16
  v_exp_f32 v40, v40
  v_exp_f32 v41, v41
  v_exp_f32 v42, v42
  v_exp_f32 v43, v43
  v_exp_f32 v44, v44
  v_exp_f32 v45, v45
  v_exp_f32 v46, v46
  v_exp_f32 v47, v47
  s_waitcnt vmcnt(7)
  s_cmpk_gt_i32 s45, 0x12c
  s_cbranch_scc1 L_k_15
  s_waitcnt vmcnt(6)
  s_cmpk_gt_i32 s45, 0x78
  s_cbranch_scc1 L_k_15
  s_waitcnt vmcnt(5)
  s_cmpk_gt_i32 s45, 0xf
  s_cbranch_scc1 L_k_15
  s_waitcnt vmcnt(4)
  s_cmpk_gt_i32 s45, 0xff38
  s_cbranch_scc1 L_k_15
  s_waitcnt vmcnt(3)
L_k_15:
  buffer_load_dwordx4 v[120:123], v2, s[8:11], s12 offen offset:0 nt
  v_add_f32 v49, v40, v41
  v_add_f32 v49, v49, v42
  v_add_f32 v49, v49, v43
  v_add_f32 v49, v49, v44
  v_add_f32 v49, v49, v45
  v_add_f32 v49, v49, v46
  v_add_f32 v49, v49, v47
  s_waitcnt vmcnt(7)
  s_cmpk_gt_i32 s45, 0x12c
  s_cbranch_scc1 L_k_16
  s_waitcnt vmcnt(6)
  s_cmpk_gt_i32 s45, 0x78
  s_cbranch_scc1 L_k_16
  s_waitcnt vmcnt(5)
  s_cmpk_gt_i32 s45, 0xf
  s_cbranch_scc1 L_k_16
  s_waitcnt vmcnt(4)
  s_cmpk_gt_i32 s45, 0xff38
  s_cbranch_scc1 L_k_16
  s_waitcnt vmcnt(3)
L_k_16:
  buffer_load_dwordx4 v[124:127], v2, s[8:11], s12 offen offset:128 nt
  ds_read_b32 v15, v4 offset:32
  s_memrealtime s[56:57]
  v_cvt_pk_bf16_f32 v40, v40, v40
  v_cvt_pk_bf16_f32 v41, v41, v41
  v_cvt_pk_bf16_f32 v42, v42, v42
  v_cvt_pk_bf16_f32 v43, v43, v43
  v_cvt_pk_bf16_f32 v44, v44, v44
  v_cvt_pk_bf16_f32 v45, v45, v45
  v_cvt_pk_bf16_f32 v46, v46, v46
  v_cvt_pk_bf16_f32 v47, v47, v47
  s_waitcnt lgkmcnt(0)
  v_readfirstlane_b32 s31, v15
  s_mul_i32 s56, s56, 205
  s_lshr_b32 s56, s56, 6
  s_sub_u32 s56, s56, s30
  s_addk_i32 s30, 128
  s_add_u32 s56, s56, s31
  s_sext_i32_i16 s56, s56
  s_bitcmp0_b32 s31, 31
  s_cselect_b32 s45, s56, s45
  s_waitcnt vmcnt(7)
  s_cmpk_gt_i32 s45, 0x12c
  s_cbranch_scc1 L_k_17
  s_waitcnt vmcnt(6)
  s_cmpk_gt_i32 s45, 0x78
  s_cbranch_scc1 L_k_17
  s_waitcnt vmcnt(5)
  s_cmpk_gt_i32 s45, 0xf
  s_cbranch_scc1 L_k_17
  s_waitcnt vmcnt(4)
  s_cmpk_gt_i32 s45, 0xff38
  s_cbranch_scc1 L_k_17
  s_waitcnt vmcnt(3)
L_k_17:
  buffer_load_dwordx4 v[128:131], v2, s[8:11], s12 offen offset:256 nt
  s_sub_u32 s12, s12, 1966080
  v_add_u32 v14, 1, v14
  ds_write_b32 v13, v14 offset:16
  ds_write_b128 v9, v[40:43]
  ds_write_b128 v9, v[44:47] offset:16
  v_add_u32 v9, 32, v9
  s_waitcnt vmcnt(7)
  s_cmpk_gt_i32 s45, 0x12c
  s_cbranch_scc1 L_k_18
  s_waitcnt vmcnt(6)
  s_cmpk_gt_i32 s45, 0x78
  s_cbranch_scc1 L_k_18
  s_waitcnt vmcnt(5)
  s_cmpk_gt_i32 s45, 0xf
  s_cbranch_scc1 L_k_18
  s_waitcnt vmcnt(4)
  s_cmpk_gt_i32 s45, 0xff38
  s_cbranch_scc1 L_k_18
  s_waitcnt vmcnt(3)
L_k_18:
  buffer_load_dwordx4 v[132:135], v2, s[8:11], s12 offen offset:0 nt
  s_nop 1
  v_add_f32_dpp v49, v49, v49 row_ror:8 row_mask:0xf bank_mask:0xf
  v_mov_b32 v6, v49
  s_nop 1
  v_permlane16_swap_b32 v49, v6
  s_nop 0
  v_add_f32 v49, v49, v6
  v_mov_b32 v6, v49
  s_nop 1
  v_permlane32_swap_b32 v49, v6
  s_nop 0
  v_add_f32 v49, v49, v6
  s_waitcnt vmcnt(7)
  s_cmpk_gt_i32 s45, 0x12c
  s_cbranch_scc1 L_k_19
  s_waitcnt vmcnt(6)
  s_cmpk_gt_i32 s45, 0x78
  s_cbranch_scc1 L_k_19
  s_waitcnt vmcnt(5)
  s_cmpk_gt_i32 s45, 0xf
  s_cbranch_scc1 L_k_19
  s_waitcnt vmcnt(4)
  s_cmpk_gt_i32 s45, 0xff38
  s_cbranch_scc1 L_k_19
  s_waitcnt vmcnt(3)
L_k_19:
  buffer_load_dwordx4 v[136:139], v2, s[8:11], s12 offen offset:128 nt
  ds_read_b32 v15, v4 offset:32
  s_memrealtime s[56:57]
  s_waitcnt lgkmcnt(0)
  v_readfirstlane_b32 s31, v15
  s_mul_i32 s56, s56, 205
  s_lshr_b32 s56, s56, 6
  s_sub_u32 s56, s56, s30
  s_addk_i32 s30, 128
  s_add_u32 s56, s56, s31
  s_sext_i32_i16 s56, s56
  s_bitcmp0_b32 s31, 31
  s_cselect_b32 s45, s56, s45
  s_waitcnt vmcnt(7)
  s_cmpk_gt_i32 s45, 0x12c
  s_cbranch_scc1 L_k_20
  s_waitcnt vmcnt(6)
  s_cmpk_gt_i32 s45, 0x78
  s_cbranch_scc1 L_k_20
  s_waitcnt vmcnt(5)
  s_cmpk_gt_i32 s45, 0xf
  s_cbranch_scc1 L_k_20
  s_waitcnt vmcnt(4)
  s_cmpk_gt_i32 s45, 0xff38
  s_cbranch_scc1 L_k_20
  s_waitcnt vmcnt(3)
L_k_20:
  buffer_load_dwordx4 v[140:143], v2, s[8:11], s12 offen offset:256 nt
  s_add_u32 s12, s12, 1179648
  v_add_u32 v14, 1, v14
  ds_write_b32 v13, v14 offset:16
  ds_write_b64 v12, v[48:49] offset:1088
  v_add_u32 v12, 32, v12
  s_waitcnt vmcnt(7)
  s_cmpk_gt_i32 s45, 0x12c
  s_cbranch_scc1 L_k_21
  s_waitcnt vmcnt(6)
  s_cmpk_gt_i32 s45, 0x78
  s_cbranch_scc1 L_k_21
  s_waitcnt vmcnt(5)
  s_cmpk_gt_i32 s45, 0xf
  s_cbranch_scc1 L_k_21
  s_waitcnt vmcnt(4)
  s_cmpk_gt_i32 s45, 0xff38
  s_cbranch_scc1 L_k_21
  s_waitcnt vmcnt(3)
L_k_21:
  buffer_load_dwordx4 v[144:147], v2, s[8:11], s12 offen offset:0 nt
  s_waitcnt vmcnt(7)
  s_cmpk_gt_i32 s45, 0x12c
  s_cbranch_scc1 L_k_22
  s_waitcnt vmcnt(6)
  s_cmpk_gt_i32 s45, 0x78
  s_cbranch_scc1 L_k_22
  s_waitcnt vmcnt(5)
  s_cmpk_gt_i32 s45, 0xf
  s_cbranch_scc1 L_k_22
  s_waitcnt vmcnt(4)
  s_cmpk_gt_i32 s45, 0xff38
  s_cbranch_scc1 L_k_22
  s_waitcnt vmcnt(3)
L_k_22:
  buffer_load_dwordx4 v[148:151], v2, s[8:11], s12 offen offset:128 nt
  ds_read_b32 v15, v4 offset:32
  s_memrealtime s[56:57]
  s_waitcnt lgkmcnt(0)
  v_readfirstlane_b32 s31, v15
  s_mul_i32 s56, s56, 205
  s_lshr_b32 s56, s56, 6
  s_sub_u32 s56, s56, s30
  s_addk_i32 s30, 128
  s_add_u32 s56, s56, s31
  s_sext_i32_i16 s56, s56
  s_bitcmp0_b32 s31, 31
  s_cselect_b32 s45, s56, s45
  s_waitcnt vmcnt(7)
  s_cmpk_gt_i32 s45, 0x12c
  s_cbranch_scc1 L_k_23
  s_waitcnt vmcnt(6)
  s_cmpk_gt_i32 s45, 0x78
  s_cbranch_scc1 L_k_23
  s_waitcnt vmcnt(5)
  s_cmpk_gt_i32 s45, 0xf
  s_cbranch_scc1 L_k_23
  s_waitcnt vmcnt(4)
  s_cmpk_gt_i32 s45, 0xff38
  s_cbranch_scc1 L_k_23
  s_waitcnt vmcnt(3)
L_k_23:
  buffer_load_dwordx4 v[152:155], v2, s[8:11], s12 offen offset:256 nt
  v_add_u32 v14, 1, v14
  ds_write_b32 v13, v14 offset:16
  s_add_u32 s44, s44, 1
  s_and_b32 s47, s44, 7
  s_cbranch_scc1 L_kloop
L_hop_0:
  s_cbranch_execz L_hop_1
  v_subrev_u32 v9, 256, v9
  ds_read_b128 v[40:43], v9
  ds_read_b128 v[44:47], v9 offset:16
  s_waitcnt lgkmcnt(0)
L_vloop:
  s_add_u32 s47, s44, 1
  s_and_b32 s47, s47, 7
  s_cbranch_scc1 L_vsw
  s_mov_b32 s8, s16
  s_mov_b32 s9, s17
  s_mov_b32 s16, s18
  s_mov_b32 s17, s19
  s_mov_b32 s18, s20
  s_mov_b32 s19, s21
L_vsw:
  s_mul_i32 s47, s47, 25165824
  s_add_u32 s12, s13, s47
  v_and_b32 v20, v40, v16
  v_and_b32 v21, v40, v17
  v_and_b32 v22, v40, v18
  v_and_b32 v23, v40, v19
  s_waitcnt vmcnt(21)
  s_nop 0
  v_mfma_f32_16x16x32_bf16 v[48:51], v[20:23], v[60:63], 0
  v_mfma_f32_16x16x32_bf16 v[52:55], v[20:23], v[64:67], 0
L_hop_1:
  s_cbranch_execz L_hop_2
  v_mfma_f32_16x16x32_bf16 v[56:59], v[20:23], v[68:71], 0
  s_waitcnt vmcnt(7)
  s_cmpk_gt_i32 s45, 0x12c
  s_cbranch_scc1 L_v_0
  s_waitcnt vmcnt(6)
  s_cmpk_gt_i32 s45, 0x78
  s_cbranch_scc1 L_v_0
  s_waitcnt vmcnt(5)
  s_cmpk_gt_i32 s45, 0xf
  s_cbranch_scc1 L_v_0
  s_waitcnt vmcnt(4)
  s_cmpk_gt_i32 s45, 0xff38
  s_cbranch_scc1 L_v_0
  s_waitcnt vmcnt(3)
L_v_0:
  buffer_load_dwordx4 v[60:63], v2, s[8:11], s12 offen offset:0 nt
  v_and_b32 v24, v41, v16
  v_and_b32 v25, v41, v17
  v_and_b32 v26, v41, v18
  v_and_b32 v27, v41, v19
  s_waitcnt vmcnt(19)
  s_nop 0
  v_mfma_f32_16x16x32_bf16 v[48:51], v[24:27], v[72:75], v[48:51]
  v_mfma_f32_16x16x32_bf16 v[52:55], v[24:27], v[76:79], v[52:55]
  v_mfma_f32_16x16x32_bf16 v[56:59], v[24:27], v[80:83], v[56:59]
L_hop_2:
  s_cbranch_execz L_hop_3
  s_waitcnt vmcnt(7)
  s_cmpk_gt_i32 s45, 0x12c
  s_cbranch_scc1 L_v_1
  s_waitcnt vmcnt(6)
  s_cmpk_gt_i32 s45, 0x78
  s_cbranch_scc1 L_v_1
  s_waitcnt vmcnt(5)
  s_cmpk_gt_i32 s45, 0xf
  s_cbranch_scc1 L_v_1
  s_waitcnt vmcnt(4)
  s_cmpk_gt_i32 s45, 0xff38
  s_cbranch_scc1 L_v_1
  s_waitcnt vmcnt(3)
L_v_1:
  buffer_load_dwordx4 v[64:67], v2, s[8:11], s12 offen offset:128 nt
  ds_read_b32 v15, v4 offset:32
  s_memrealtime s[56:57]
  s_waitcnt lgkmcnt(0)
  v_readfirstlane_b32 s31, v15
  s_mul_i32 s56, s56, 205
  s_lshr_b32 s56, s56, 6
  s_sub_u32 s56, s56, s30
  s_addk_i32 s30, 128
  s_add_u32 s56, s56, s31
  s_sext_i32_i16 s56, s56
  s_bitcmp0_b32 s31, 31
L_hop_3:
  s_cbranch_execz L_hop_4
  s_cselect_b32 s45, s56, s45
  s_waitcnt vmcnt(7)
  s_cmpk_gt_i32 s45, 0x12c
  s_cbranch_scc1 L_v_2
  s_waitcnt vmcnt(6)
  s_cmpk_gt_i32 s45, 0x78
  s_cbranch_scc1 L_v_2
  s_waitcnt vmcnt(5)
  s_cmpk_gt_i32 s45, 0xf
  s_cbranch_scc1 L_v_2
  s_waitcnt vmcnt(4)
  s_cmpk_gt_i32 s45, 0xff38
  s_cbranch_scc1 L_v_2
  s_waitcnt vmcnt(3)
L_v_2:
  buffer_load_dwordx4 v[68:71], v2, s[8:11], s12 offen offset:256 nt
  s_add_u32 s12, s12, 1179648
  v_add_u32 v14, 1, v14
  ds_write_b32 v13, v14 offset:16
  v_and_b32 v20, v42, v16
  v_and_b32 v21, v42, v17
  v_and_b32 v22, v42, v18
  v_and_b32 v23, v42, v19
  s_waitcnt vmcnt(18)
  s_nop 0
  v_mfma_f32_16x16x32_bf16 v[48:51], v[20:23], v[84:87], v[48:51]
L_hop_4:
  s_cbranch_execz L_hop_5
  v_mfma_f32_16x16x32_bf16 v[52:55], v[20:23], v[88:91], v[52:55]
  v_mfma_f32_16x16x32_bf16 v[56:59], v[20:23], v[92:95], v[56:59]
  s_waitcnt vmcnt(7)
  s_cmpk_gt_i32 s45, 0x12c
  s_cbranch_scc1 L_v_3
  s_waitcnt vmcnt(6)
  s_cmpk_gt_i32 s45, 0x78
  s_cbranch_scc1 L_v_3
  s_waitcnt vmcnt(5)
  s_cmpk_gt_i32 s45, 0xf
  s_cbranch_scc1 L_v_3
  s_waitcnt vmcnt(4)
  s_cmpk_gt_i32 s45, 0xff38
  s_cbranch_scc1 L_v_3
  s_waitcnt vmcnt(3)
L_v_3:
  buffer_load_dwordx4 v[72:75], v2, s[8:11], s12 offen offset:0 nt
  v_and_b32 v24, v43, v16
  v_and_b32 v25, v43, v17
  v_and_b32 v26, v43, v18
  v_and_b32 v27, v43, v19
  s_waitcnt vmcnt(16)
  s_nop 0
  v_mfma_f32_16x16x32_bf16 v[48:51], v[24:27], v[96:99], v[48:51]
  v_mfma_f32_16x16x32_bf16 v[52:55], v[24:27], v[100:103], v[52:55]
L_hop_5:
  s_cbranch_execz L_hop_6
  v_mfma_f32_16x16x32_bf16 v[56:59], v[24:27], v[104:107], v[56:59]
  s_waitcnt vmcnt(7)
  s_cmpk_gt_i32 s45, 0x12c
  s_cbranch_scc1 L_v_4
  s_waitcnt vmcnt(6)
  s_cmpk_gt_i32 s45, 0x78
  s_cbranch_scc1 L_v_4
  s_waitcnt vmcnt(5)
  s_cmpk_gt_i32 s45, 0xf
  s_cbranch_scc1 L_v_4
  s_waitcnt vmcnt(4)
  s_cmpk_gt_i32 s45, 0xff38
  s_cbranch_scc1 L_v_4
  s_waitcnt vmcnt(3)
L_v_4:
  buffer_load_dwordx4 v[76:79], v2, s[8:11], s12 offen offset:128 nt
  ds_read_b32 v15, v4 offset:32
  s_memrealtime s[56:57]
  s_waitcnt lgkmcnt(0)
  v_readfirstlane_b32 s31, v15
  s_mul_i32 s56, s56, 205
  s_lshr_b32 s56, s56, 6
  s_sub_u32 s56, s56, s30
  s_addk_i32 s30, 128
  s_add_u32 s56, s56, s31
L_hop_6:
  s_cbranch_execz L_hop_7
  s_sext_i32_i16 s56, s56
  s_bitcmp0_b32 s31, 31
  s_cselect_b32 s45, s56, s45
  s_waitcnt vmcnt(7)
  s_cmpk_gt_i32 s45, 0x12c
  s_cbranch_scc1 L_v_5
  s_waitcnt vmcnt(6)
  s_cmpk_gt_i32 s45, 0x78
  s_cbranch_scc1 L_v_5
  s_waitcnt vmcnt(5)
  s_cmpk_gt_i32 s45, 0xf
  s_cbranch_scc1 L_v_5
  s_waitcnt vmcnt(4)
  s_cmpk_gt_i32 s45, 0xff38
  s_cbranch_scc1 L_v_5
  s_waitcnt vmcnt(3)
L_v_5:
  buffer_load_dwordx4 v[80:83], v2, s[8:11], s12 offen offset:256 nt
  s_add_u32 s12, s12, 1179648
  v_add_u32 v14, 1, v14
  ds_write_b32 v13, v14 offset:16
  v_and_b32 v20, v44, v16
  v_and_b32 v21, v44, v17
  v_and_b32 v22, v44, v18
  v_and_b32 v23, v44, v19
  s_waitcnt vmcnt(15)
  s_nop 0
L_hop_7:
  s_cbranch_execz L_hop_8
  v_mfma_f32_16x16x32_bf16 v[48:51], v[20:23], v[108:111], v[48:51]
  v_mfma_f32_16x16x32_bf16 v[52:55], v[20:23], v[112:115], v[52:55]
  v_mfma_f32_16x16x32_bf16 v[56:59], v[20:23], v[116:119], v[56:59]
  s_waitcnt vmcnt(7)
  s_cmpk_gt_i32 s45, 0x12c
  s_cbranch_scc1 L_v_6
  s_waitcnt vmcnt(6)
  s_cmpk_gt_i32 s45, 0x78
  s_cbranch_scc1 L_v_6
  s_waitcnt vmcnt(5)
  s_cmpk_gt_i32 s45, 0xf
  s_cbranch_scc1 L_v_6
  s_waitcnt vmcnt(4)
  s_cmpk_gt_i32 s45, 0xff38
  s_cbranch_scc1 L_v_6
  s_waitcnt vmcnt(3)
L_v_6:
  buffer_load_dwordx4 v[84:87], v2, s[8:11], s12 offen offset:0 nt
  v_and_b32 v24, v45, v16
  v_and_b32 v25, v45, v17
  v_and_b32 v26, v45, v18
  v_and_b32 v27, v45, v19
  s_waitcnt vmcnt(13)
  s_nop 0
  v_mfma_f32_16x16x32_bf16 v[48:51], v[24:27], v[120:123], v[48:51]
L_hop_8:
  s_cbranch_execz L_hop_9
  v_mfma_f32_16x16x32_bf16 v[52:55], v[24:27], v[124:127], v[52:55]
  v_mfma_f32_16x16x32_bf16 v[56:59], v[24:27], v[128:131], v[56:59]
  s_waitcnt vmcnt(7)
  s_cmpk_gt_i32 s45, 0x12c
  s_cbranch_scc1 L_v_7
  s_waitcnt vmcnt(6)
  s_cmpk_gt_i32 s45, 0x78
  s_cbranch_scc1 L_v_7
  s_waitcnt vmcnt(5)
  s_cmpk_gt_i32 s45, 0xf
  s_cbranch_scc1 L_v_7
  s_waitcnt vmcnt(4)
  s_cmpk_gt_i32 s45, 0xff38
  s_cbranch_scc1 L_v_7
  s_waitcnt vmcnt(3)
L_v_7:
  buffer_load_dwordx4 v[88:91], v2, s[8:11], s12 offen offset:128 nt
  ds_read_b32 v15, v4 offset:32
  s_memrealtime s[56:57]
  s_waitcnt lgkmcnt(0)
  v_readfirstlane_b32 s31, v15
  s_mul_i32 s56, s56, 205
  s_lshr_b32 s56, s56, 6
  s_sub_u32 s56, s56, s30
L_hop_9:
  s_cbranch_execz L_hop_10
  s_addk_i32 s30, 128
  s_add_u32 s56, s56, s31
  s_sext_i32_i16 s56, s56
  s_bitcmp0_b32 s31, 31
  s_cselect_b32 s45, s56, s45
  s_waitcnt vmcnt(7)
  s_cmpk_gt_i32 s45, 0x12c
  s_cbranch_scc1 L_v_8
  s_waitcnt vmcnt(6)
  s_cmpk_gt_i32 s45, 0x78
  s_cbranch_scc1 L_v_8
  s_waitcnt vmcnt(5)
  s_cmpk_gt_i32 s45, 0xf
  s_cbranch_scc1 L_v_8
  s_waitcnt vmcnt(4)
  s_cmpk_gt_i32 s45, 0xff38
  s_cbranch_scc1 L_v_8
  s_waitcnt vmcnt(3)
L_v_8:
  buffer_load_dwordx4 v[92:95], v2, s[8:11], s12 offen offset:256 nt
  s_sub_u32 s12, s12, 1966080
  v_add_u32 v14, 1, v14
  ds_write_b32 v13, v14 offset:16
  v_and_b32 v20, v46, v16
  v_and_b32 v21, v46, v17
  v_and_b32 v22, v46, v18
  v_and_b32 v23, v46, v19
L_hop_10:
  s_cbranch_execz L_hop_11
  s_waitcnt vmcnt(12)
  s_nop 0
  v_mfma_f32_16x16x32_bf16 v[48:51], v[20:23], v[132:135], v[48:51]
  v_mfma_f32_16x16x32_bf16 v[52:55], v[20:23], v[136:139], v[52:55]
  v_mfma_f32_16x16x32_bf16 v[56:59], v[20:23], v[140:143], v[56:59]
  s_waitcnt vmcnt(7)
  s_cmpk_gt_i32 s45, 0x12c
  s_cbranch_scc1 L_v_9
  s_waitcnt vmcnt(6)
  s_cmpk_gt_i32 s45, 0x78
  s_cbranch_scc1 L_v_9
  s_waitcnt vmcnt(5)
  s_cmpk_gt_i32 s45, 0xf
  s_cbranch_scc1 L_v_9
  s_waitcnt vmcnt(4)
  s_cmpk_gt_i32 s45, 0xff38
  s_cbranch_scc1 L_v_9
  s_waitcnt vmcnt(3)
L_v_9:
  buffer_load_dwordx4 v[96:99], v2, s[8:11], s12 offen offset:0 nt
  v_and_b32 v24, v47, v16
  v_and_b32 v25, v47, v17
  v_and_b32 v26, v47, v18
  v_and_b32 v27, v47, v19
  s_waitcnt vmcnt(10)
  s_nop 0
L_hop_11:
  s_cbranch_execz L_hop_12
  v_mfma_f32_16x16x32_bf16 v[48:51], v[24:27], v[144:147], v[48:51]
  v_mfma_f32_16x16x32_bf16 v[52:55], v[24:27], v[148:151], v[52:55]
  v_mfma_f32_16x16x32_bf16 v[56:59], v[24:27], v[152:155], v[56:59]
  s_waitcnt vmcnt(7)
  s_cmpk_gt_i32 s45, 0x12c
  s_cbranch_scc1 L_v_10
  s_waitcnt vmcnt(6)
  s_cmpk_gt_i32 s45, 0x78
  s_cbranch_scc1 L_v_10
  s_waitcnt vmcnt(5)
  s_cmpk_gt_i32 s45, 0xf
  s_cbranch_scc1 L_v_10
  s_waitcnt vmcnt(4)
  s_cmpk_gt_i32 s45, 0xff38
  s_cbranch_scc1 L_v_10
  s_waitcnt vmcnt(3)
L_v_10:
  buffer_load_dwordx4 v[100:103], v2, s[8:11], s12 offen offset:128 nt
  ds_read_b32 v15, v4 offset:32
  s_memrealtime s[56:57]
  s_waitcnt lgkmcnt(0)
  v_readfirstlane_b32 s31, v15
  s_mul_i32 s56, s56, 205
L_hop_12:
  s_cbranch_execz L_hop_13
  s_lshr_b32 s56, s56, 6
  s_sub_u32 s56, s56, s30
  s_addk_i32 s30, 128
  s_add_u32 s56, s56, s31
  s_sext_i32_i16 s56, s56
  s_bitcmp0_b32 s31, 31
  s_cselect_b32 s45, s56, s45
  s_waitcnt vmcnt(7)
  s_cmpk_gt_i32 s45, 0x12c
  s_cbranch_scc1 L_v_11
  s_waitcnt vmcnt(6)
  s_cmpk_gt_i32 s45, 0x78
  s_cbranch_scc1 L_v_11
  s_waitcnt vmcnt(5)
  s_cmpk_gt_i32 s45, 0xf
  s_cbranch_scc1 L_v_11
  s_waitcnt vmcnt(4)
  s_cmpk_gt_i32 s45, 0xff38
  s_cbranch_scc1 L_v_11
  s_waitcnt vmcnt(3)
L_v_11:
  buffer_load_dwordx4 v[104:107], v2, s[8:11], s12 offen offset:256 nt
  s_add_u32 s12, s12, 1179648
  v_add_u32 v14, 1, v14
  ds_write_b32 v13, v14 offset:16
  s_nop 7
  s_mov_b64 exec, s[54:55]
L_hop_13:
  s_cbranch_execz L_hop_14
  ds_write_b128 v11, v[48:51] offset:0
  ds_write_b128 v11, v[52:55] offset:256
  ds_write_b128 v11, v[56:59] offset:512
  s_mov_b64 exec, -1
  v_add_u32 v11, 6144, v11
  v_add_u32 v9, 32, v9
  s_waitcnt vmcnt(7)
  s_cmpk_gt_i32 s45, 0x12c
  s_cbranch_scc1 L_v_12
  s_waitcnt vmcnt(6)
  s_cmpk_gt_i32 s45, 0x78
  s_cbranch_scc1 L_v_12
  s_waitcnt vmcnt(5)
  s_cmpk_gt_i32 s45, 0xf
  s_cbranch_scc1 L_v_12
  s_waitcnt vmcnt(4)
  s_cmpk_gt_i32 s45, 0xff38
  s_cbranch_scc1 L_v_12
  s_waitcnt vmcnt(3)
L_v_12:
  buffer_load_dwordx4 v[108:111], v2, s[8:11], s12 offen offset:0 nt
  ds_read_b128 v[40:43], v9
  ds_read_b128 v[44:47], v9 offset:16
L_hop_14:
  s_cbranch_execz L_hop_15
  s_waitcnt vmcnt(7)
  s_cmpk_gt_i32 s45, 0x12c
  s_cbranch_scc1 L_v_13
  s_waitcnt vmcnt(6)
  s_cmpk_gt_i32 s45, 0x78
  s_cbranch_scc1 L_v_13
  s_waitcnt vmcnt(5)
  s_cmpk_gt_i32 s45, 0xf
  s_cbranch_scc1 L_v_13
  s_waitcnt vmcnt(4)
  s_cmpk_gt_i32 s45, 0xff38
  s_cbranch_scc1 L_v_13
  s_waitcnt vmcnt(3)
L_v_13:
  buffer_load_dwordx4 v[112:115], v2, s[8:11], s12 offen offset:128 nt
  ds_read_b32 v15, v4 offset:32
  s_memrealtime s[56:57]
  s_waitcnt lgkmcnt(0)
  v_readfirstlane_b32 s31, v15
  s_mul_i32 s56, s56, 205
  s_lshr_b32 s56, s56, 6
  s_sub_u32 s56, s56, s30
  s_addk_i32 s30, 128
  s_add_u32 s56, s56, s31
  s_sext_i32_i16 s56, s56
  s_bitcmp0_b32 s31, 31
L_hop_15:
  s_cbranch_execz L_hop_16
  s_cselect_b32 s45, s56, s45
  s_waitcnt vmcnt(7)
  s_cmpk_gt_i32 s45, 0x12c
  s_cbranch_scc1 L_v_14
  s_waitcnt vmcnt(6)
  s_cmpk_gt_i32 s45, 0x78
  s_cbranch_scc1 L_v_14
  s_waitcnt vmcnt(5)
  s_cmpk_gt_i32 s45, 0xf
  s_cbranch_scc1 L_v_14
  s_waitcnt vmcnt(4)
  s_cmpk_gt_i32 s45, 0xff38
  s_cbranch_scc1 L_v_14
  s_waitcnt vmcnt(3)
L_v_14:
  buffer_load_dwordx4 v[116:119], v2, s[8:11], s12 offen offset:256 nt
  s_add_u32 s12, s12, 1179648
  v_add_u32 v14, 1, v14
  ds_write_b32 v13, v14 offset:16
  s_waitcnt vmcnt(7)
  s_cmpk_gt_i32 s45, 0x12c
  s_cbranch_scc1 L_v_15
  s_waitcnt vmcnt(6)
  s_cmpk_gt_i32 s45, 0x78
  s_cbranch_scc1 L_v_15
  s_waitcnt vmcnt(5)
  s_cmpk_gt_i32 s45, 0xf
L_hop_16:
  s_cbranch_execz L_hop_17
  s_cbranch_scc1 L_v_15
  s_waitcnt vmcnt(4)
  s_cmpk_gt_i32 s45, 0xff38
  s_cbranch_scc1 L_v_15
  s_waitcnt vmcnt(3)
L_v_15:
  buffer_load_dwordx4 v[120:123], v2, s[8:11], s12 offen offset:0 nt
  s_waitcnt vmcnt(7)
  s_cmpk_gt_i32 s45, 0x12c
  s_cbranch_scc1 L_v_16
  s_waitcnt vmcnt(6)
  s_cmpk_gt_i32 s45, 0x78
  s_cbranch_scc1 L_v_16
  s_waitcnt vmcnt(5)
  s_cmpk_gt_i32 s45, 0xf
  s_cbranch_scc1 L_v_16
  s_waitcnt vmcnt(4)
  s_cmpk_gt_i32 s45, 0xff38
  s_cbranch_scc1 L_v_16
  s_waitcnt vmcnt(3)
L_v_16:
  buffer_load_dwordx4 v[124:127], v2, s[8:11], s12 offen offset:128 nt
  ds_read_b32 v15, v4 offset:32
  s_memrealtime s[56:57]
  s_waitcnt lgkmcnt(0)
  v_readfirstlane_b32 s31, v15
  s_mul_i32 s56, s56, 205
L_hop_17:
  s_cbranch_execz L_hop_18
  s_lshr_b32 s56, s56, 6
  s_sub_u32 s56, s56, s30
  s_addk_i32 s30, 128
  s_add_u32 s56, s56, s31
  s_sext_i32_i16 s56, s56
  s_bitcmp0_b32 s31, 31
  s_cselect_b32 s45, s56, s45
  s_waitcnt vmcnt(7)
  s_cmpk_gt_i32 s45, 0x12c
  s_cbranch_scc1 L_v_17
  s_waitcnt vmcnt(6)
  s_cmpk_gt_i32 s45, 0x78
  s_cbranch_scc1 L_v_17
  s_waitcnt vmcnt(5)
  s_cmpk_gt_i32 s45, 0xf
  s_cbranch_scc1 L_v_17
  s_waitcnt vmcnt(4)
  s_cmpk_gt_i32 s45, 0xff38
  s_cbranch_scc1 L_v_17
  s_waitcnt vmcnt(3)
L_v_17:
  buffer_load_dwordx4 v[128:131], v2, s[8:11], s12 offen offset:256 nt
  s_sub_u32 s12, s12, 1966080
  v_add_u32 v14, 1, v14
  ds_write_b32 v13, v14 offset:16
  s_waitcnt vmcnt(7)
  s_cmpk_gt_i32 s45, 0x12c
L_hop_18:
  s_cbranch_execz L_hop_19
  s_cbranch_scc1 L_v_18
  s_waitcnt vmcnt(6)
  s_cmpk_gt_i32 s45, 0x78
  s_cbranch_scc1 L_v_18
  s_waitcnt vmcnt(5)
  s_cmpk_gt_i32 s45, 0xf
  s_cbranch_scc1 L_v_18
  s_waitcnt vmcnt(4)
  s_cmpk_gt_i32 s45, 0xff38
  s_cbranch_scc1 L_v_18
  s_waitcnt vmcnt(3)
L_v_18:
  buffer_load_dwordx4 v[132:135], v2, s[8:11], s12 offen offset:0 nt
  s_waitcnt vmcnt(7)
  s_cmpk_gt_i32 s45, 0x12c
  s_cbranch_scc1 L_v_19
  s_waitcnt vmcnt(6)
  s_cmpk_gt_i32 s45, 0x78
  s_cbranch_scc1 L_v_19
  s_waitcnt vmcnt(5)
  s_cmpk_gt_i32 s45, 0xf
  s_cbranch_scc1 L_v_19
  s_waitcnt vmcnt(4)
  s_cmpk_gt_i32 s45, 0xff38
  s_cbranch_scc1 L_v_19
  s_waitcnt vmcnt(3)
L_v_19:
  buffer_load_dwordx4 v[136:139], v2, s[8:11], s12 offen offset:128 nt
  ds_read_b32 v15, v4 offset:32
L_hop_19:
  s_cbranch_execz L_hop_20
  s_memrealtime s[56:57]
  s_waitcnt lgkmcnt(0)
  v_readfirstlane_b32 s31, v15
  s_mul_i32 s56, s56, 205
  s_lshr_b32 s56, s56, 6
  s_sub_u32 s56, s56, s30
  s_addk_i32 s30, 128
  s_add_u32 s56, s56, s31
  s_sext_i32_i16 s56, s56
  s_bitcmp0_b32 s31, 31
  s_cselect_b32 s45, s56, s45
  s_waitcnt vmcnt(7)
  s_cmpk_gt_i32 s45, 0x12c
  s_cbranch_scc1 L_v_20
  s_waitcnt vmcnt(6)
  s_cmpk_gt_i32 s45, 0x78
  s_cbranch_scc1 L_v_20
  s_waitcnt vmcnt(5)
  s_cmpk_gt_i32 s45, 0xf
  s_cbranch_scc1 L_v_20
  s_waitcnt vmcnt(4)
  s_cmpk_gt_i32 s45, 0xff38
  s_cbranch_scc1 L_v_20
  s_waitcnt vmcnt(3)
L_v_20:
  buffer_load_dwordx4 v[140:143], v2, s[8:11], s12 offen offset:256 nt
  s_add_u32 s12, s12, 1179648
L_hop_20:
  s_cbranch_execz L_hop_21
  v_add_u32 v14, 1, v14
  ds_write_b32 v13, v14 offset:16
  s_waitcnt vmcnt(7)
  s_cmpk_gt_i32 s45, 0x12c
  s_cbranch_scc1 L_v_21
  s_waitcnt vmcnt(6)
  s_cmpk_gt_i32 s45, 0x78
  s_cbranch_scc1 L_v_21
  s_waitcnt vmcnt(5)
  s_cmpk_gt_i32 s45, 0xf
  s_cbranch_scc1 L_v_21
  s_waitcnt vmcnt(4)
  s_cmpk_gt_i32 s45, 0xff38
  s_cbranch_scc1 L_v_21
  s_waitcnt vmcnt(3)
L_v_21:
  buffer_load_dwordx4 v[144:147], v2, s[8:11], s12 offen offset:0 nt
  s_waitcnt vmcnt(7)
  s_cmpk_gt_i32 s45, 0x12c
  s_cbranch_scc1 L_v_22
  s_waitcnt vmcnt(6)
  s_cmpk_gt_i32 s45, 0x78
  s_cbranch_scc1 L_v_22
  s_waitcnt vmcnt(5)
  s_cmpk_gt_i32 s45, 0xf
  s_cbranch_scc1 L_v_22
  s_waitcnt vmcnt(4)
  s_cmpk_gt_i32 s45, 0xff38
L_hop_21:
  s_cbranch_execz L_hop_22
  s_cbranch_scc1 L_v_22
  s_waitcnt vmcnt(3)
L_v_22:
  buffer_load_dwordx4 v[148:151], v2, s[8:11], s12 offen offset:128 nt
  ds_read_b32 v15, v4 offset:32
  s_memrealtime s[56:57]
  s_waitcnt lgkmcnt(0)
  v_readfirstlane_b32 s31, v15
  s_mul_i32 s56, s56, 205
  s_lshr_b32 s56, s56, 6
  s_sub_u32 s56, s56, s30
  s_addk_i32 s30, 128
  s_add_u32 s56, s56, s31
  s_sext_i32_i16 s56, s56
  s_bitcmp0_b32 s31, 31
  s_cselect_b32 s45, s56, s45
  s_waitcnt vmcnt(7)
  s_cmpk_gt_i32 s45, 0x12c
  s_cbranch_scc1 L_v_23
  s_waitcnt vmcnt(6)
  s_cmpk_gt_i32 s45, 0x78
  s_cbranch_scc1 L_v_23
  s_waitcnt vmcnt(5)
  s_cmpk_gt_i32 s45, 0xf
  s_cbranch_scc1 L_v_23
  s_waitcnt vmcnt(4)
L_hop_22:
  s_cbranch_execz L_hop_23
  s_cmpk_gt_i32 s45, 0xff38
  s_cbranch_scc1 L_v_23
  s_waitcnt vmcnt(3)
L_v_23:
  buffer_load_dwordx4 v[152:155], v2, s[8:11], s12 offen offset:256 nt
  v_add_u32 v14, 1, v14
  ds_write_b32 v13, v14 offset:16
  s_add_u32 s44, s44, 1
  s_cmp_eq_u32 s44, 31
  s_cbranch_scc1 L_last
  s_and_b32 s47, s44, 7
  s_cbranch_scc1 L_vloop
  v_subrev_u32 v9, 256, v9
  s_branch L_kloop
L_last:
  s_cmp_lt_u32 s4, 28
  s_cbranch_scc1 L_last1
  v_and_b32 v20, v40, v16
  v_and_b32 v21, v40, v17
  v_and_b32 v22, v40, v18
  v_and_b32 v23, v40, v19
  s_waitcnt vmcnt(21)
  s_nop 0
  v_mfma_f32_16x16x32_bf16 v[48:51], v[20:23], v[60:63], 0
  v_mfma_f32_16x16x32_bf16 v[52:55], v[20:23], v[64:67], 0
  v_mfma_f32_16x16x32_bf16 v[56:59], v[20:23], v[68:71], 0
L_hop_23:
  s_cbranch_execz L_hop_24
  v_and_b32 v24, v41, v16
  v_and_b32 v25, v41, v17
  v_and_b32 v26, v41, v18
  v_and_b32 v27, v41, v19
  s_waitcnt vmcnt(18)
  s_nop 0
  v_mfma_f32_16x16x32_bf16 v[48:51], v[24:27], v[72:75], v[48:51]
  v_mfma_f32_16x16x32_bf16 v[52:55], v[24:27], v[76:79], v[52:55]
  v_mfma_f32_16x16x32_bf16 v[56:59], v[24:27], v[80:83], v[56:59]
  v_and_b32 v20, v42, v16
  v_and_b32 v21, v42, v17
  v_and_b32 v22, v42, v18
  v_and_b32 v23, v42, v19
  s_waitcnt vmcnt(15)
  s_nop 0
  v_mfma_f32_16x16x32_bf16 v[48:51], v[20:23], v[84:87], v[48:51]
  v_mfma_f32_16x16x32_bf16 v[52:55], v[20:23], v[88:91], v[52:55]
  v_mfma_f32_16x16x32_bf16 v[56:59], v[20:23], v[92:95], v[56:59]
  v_and_b32 v24, v43, v16
  v_and_b32 v25, v43, v17
  v_and_b32 v26, v43, v18
  v_and_b32 v27, v43, v19
  s_waitcnt vmcnt(12)
L_hop_24:
  s_cbranch_execz L_hop_25
  s_nop 0
  v_mfma_f32_16x16x32_bf16 v[48:51], v[24:27], v[96:99], v[48:51]
  v_mfma_f32_16x16x32_bf16 v[52:55], v[24:27], v[100:103], v[52:55]
  v_mfma_f32_16x16x32_bf16 v[56:59], v[24:27], v[104:107], v[56:59]
  v_and_b32 v20, v44, v16
  v_and_b32 v21, v44, v17
  v_and_b32 v22, v44, v18
  v_and_b32 v23, v44, v19
  s_waitcnt vmcnt(9)
  s_nop 0
  v_mfma_f32_16x16x32_bf16 v[48:51], v[20:23], v[108:111], v[48:51]
  v_mfma_f32_16x16x32_bf16 v[52:55], v[20:23], v[112:115], v[52:55]
  v_mfma_f32_16x16x32_bf16 v[56:59], v[20:23], v[116:119], v[56:59]
  v_and_b32 v24, v45, v16
  v_and_b32 v25, v45, v17
  v_and_b32 v26, v45, v18
  v_and_b32 v27, v45, v19
  s_waitcnt vmcnt(6)
  s_nop 0
  v_mfma_f32_16x16x32_bf16 v[48:51], v[24:27], v[120:123], v[48:51]
  v_mfma_f32_16x16x32_bf16 v[52:55], v[24:27], v[124:127], v[52:55]
L_hop_25:
  s_cbranch_execz L_hop_26
  v_mfma_f32_16x16x32_bf16 v[56:59], v[24:27], v[128:131], v[56:59]
  v_and_b32 v20, v46, v16
  v_and_b32 v21, v46, v17
  v_and_b32 v22, v46, v18
  v_and_b32 v23, v46, v19
  s_waitcnt vmcnt(3)
  s_nop 0
  v_mfma_f32_16x16x32_bf16 v[48:51], v[20:23], v[132:135], v[48:51]
  v_mfma_f32_16x16x32_bf16 v[52:55], v[20:23], v[136:139], v[52:55]
  v_mfma_f32_16x16x32_bf16 v[56:59], v[20:23], v[140:143], v[56:59]
  v_and_b32 v24, v47, v16
  v_and_b32 v25, v47, v17
  v_and_b32 v26, v47, v18
  v_and_b32 v27, v47, v19
  s_waitcnt vmcnt(0)
  s_nop 0
  v_mfma_f32_16x16x32_bf16 v[48:51], v[24:27], v[144:147], v[48:51]
  v_mfma_f32_16x16x32_bf16 v[52:55], v[24:27], v[148:151], v[52:55]
  v_mfma_f32_16x16x32_bf16 v[56:59], v[24:27], v[152:155], v[56:59]
  v_add_u32 v14, 8, v14
  s_nop 5
  s_mov_b64 exec, s[54:55]
L_hop_26:
  s_cbranch_execz L_hop_27
  ds_write_b128 v11, v[48:51] offset:0
  ds_write_b128 v11, v[52:55] offset:256
  ds_write_b128 v11, v[56:59] offset:512
  s_mov_b64 exec, -1
  ds_write_b32 v13, v14 offset:16
  s_branch L_proj
L_last1:
  s_waitcnt vmcnt(4)
  buffer_load_dwordx4 a[0:3], v3, s[24:27], s28 offen nt
  s_addk_i32 s28, 5120
  v_and_b32 v20, v40, v16
  v_and_b32 v21, v40, v17
  v_and_b32 v22, v40, v18
  v_and_b32 v23, v40, v19
  s_waitcnt vmcnt(22)
  s_nop 0
  v_mfma_f32_16x16x32_bf16 v[48:51], v[20:23], v[60:63], 0
  v_mfma_f32_16x16x32_bf16 v[52:55], v[20:23], v[64:67], 0
  v_mfma_f32_16x16x32_bf16 v[56:59], v[20:23], v[68:71], 0
  v_and_b32 v24, v41, v16
  v_and_b32 v25, v41, v17
  v_and_b32 v26, v41, v18
L_hop_27:
  s_cbranch_execz L_hop_28
  v_and_b32 v27, v41, v19
  s_waitcnt vmcnt(19)
  s_nop 0
  v_mfma_f32_16x16x32_bf16 v[48:51], v[24:27], v[72:75], v[48:51]
  v_mfma_f32_16x16x32_bf16 v[52:55], v[24:27], v[76:79], v[52:55]
  v_mfma_f32_16x16x32_bf16 v[56:59], v[24:27], v[80:83], v[56:59]
  s_waitcnt vmcnt(4)
  buffer_load_dwordx4 a[4:7], v3, s[24:27], s28 offen nt
  s_addk_i32 s28, 5120
  v_and_b32 v20, v42, v16
  v_and_b32 v21, v42, v17
  v_and_b32 v22, v42, v18
  v_and_b32 v23, v42, v19
  s_waitcnt vmcnt(17)
  s_nop 0
  v_mfma_f32_16x16x32_bf16 v[48:51], v[20:23], v[84:87], v[48:51]
  v_mfma_f32_16x16x32_bf16 v[52:55], v[20:23], v[88:91], v[52:55]
  v_mfma_f32_16x16x32_bf16 v[56:59], v[20:23], v[92:95], v[56:59]
  v_and_b32 v24, v43, v16
  v_and_b32 v25, v43, v17
  v_and_b32 v26, v43, v18
  v_and_b32 v27, v43, v19
L_hop_28:
  s_cbranch_execz L_hop_29
  s_waitcnt vmcnt(14)
  s_nop 0
  v_mfma_f32_16x16x32_bf16 v[48:51], v[24:27], v[96:99], v[48:51]
  v_mfma_f32_16x16x32_bf16 v[52:55], v[24:27], v[100:103], v[52:55]
  v_mfma_f32_16x16x32_bf16 v[56:59], v[24:27], v[104:107], v[56:59]
  s_waitcnt vmcnt(4)
  buffer_load_dwordx4 a[8:11], v3, s[24:27], s28 offen nt
  s_addk_i32 s28, 5120
  v_and_b32 v20, v44, v16
  v_and_b32 v21, v44, v17
  v_and_b32 v22, v44, v18
  v_and_b32 v23, v44, v19
  s_waitcnt vmcnt(12)
  s_nop 0
  v_mfma_f32_16x16x32_bf16 v[48:51], v[20:23], v[108:111], v[48:51]
  v_mfma_f32_16x16x32_bf16 v[52:55], v[20:23], v[112:115], v[52:55]
  v_mfma_f32_16x16x32_bf16 v[56:59], v[20:23], v[116:119], v[56:59]
  v_and_b32 v24, v45, v16
  v_and_b32 v25, v45, v17
  v_and_b32 v26, v45, v18
  v_and_b32 v27, v45, v19
  s_waitcnt vmcnt(9)
L_hop_29:
  s_cbranch_execz L_hop_30
  s_nop 0
  v_mfma_f32_16x16x32_bf16 v[48:51], v[24:27], v[120:123], v[48:51]
  v_mfma_f32_16x16x32_bf16 v[52:55], v[24:27], v[124:127], v[52:55]
  v_mfma_f32_16x16x32_bf16 v[56:59], v[24:27], v[128:131], v[56:59]
  s_waitcnt vmcnt(4)
  buffer_load_dwordx4 a[12:15], v3, s[24:27], s28 offen nt
  s_add_u32 s28, s28, 66560
  v_and_b32 v20, v46, v16
  v_and_b32 v21, v46, v17
  v_and_b32 v22, v46, v18
  v_and_b32 v23, v46, v19
  s_waitcnt vmcnt(7)
  s_nop 0
  v_mfma_f32_16x16x32_bf16 v[48:51], v[20:23], v[132:135], v[48:51]
  v_mfma_f32_16x16x32_bf16 v[52:55], v[20:23], v[136:139], v[52:55]
  v_mfma_f32_16x16x32_bf16 v[56:59], v[20:23], v[140:143], v[56:59]
  s_waitcnt vmcnt(4)
  buffer_load_dwordx4 a[16:19], v3, s[24:27], s28 offen nt
  s_addk_i32 s28, 5120
  v_and_b32 v24, v47, v16
L_hop_30:
  s_cbranch_execz L_hop_31
  v_and_b32 v25, v47, v17
  v_and_b32 v26, v47, v18
  v_and_b32 v27, v47, v19
  s_waitcnt vmcnt(5)
  s_nop 0
  v_mfma_f32_16x16x32_bf16 v[48:51], v[24:27], v[144:147], v[48:51]
  v_mfma_f32_16x16x32_bf16 v[52:55], v[24:27], v[148:151], v[52:55]
  v_mfma_f32_16x16x32_bf16 v[56:59], v[24:27], v[152:155], v[56:59]
  v_add_u32 v14, 8, v14
  s_nop 5
  s_mov_b64 exec, s[54:55]
  ds_write_b128 v11, v[48:51] offset:0
  ds_write_b128 v11, v[52:55] offset:256
  ds_write_b128 v11, v[56:59] offset:512
  s_mov_b64 exec, -1
  ds_write_b32 v13, v14 offset:16
  s_waitcnt vmcnt(4)
  buffer_load_dwordx4 a[20:23], v3, s[24:27], s28 offen nt
  s_addk_i32 s28, 5120
  s_waitcnt vmcnt(4)
  buffer_load_dwordx4 a[24:27], v3, s[24:27], s28 offen nt
L_hop_31:
  s_cbranch_execz L_hop_32
  s_addk_i32 s28, 5120
  s_waitcnt vmcnt(4)
  buffer_load_dwordx4 a[28:31], v3, s[24:27], s28 offen nt
  s_add_u32 s28, s28, 66560
  s_waitcnt vmcnt(4)
  buffer_load_dwordx4 a[32:35], v3, s[24:27], s28 offen nt
  s_addk_i32 s28, 5120
  s_waitcnt vmcnt(4)
  buffer_load_dwordx4 a[36:39], v3, s[24:27], s28 offen nt
  s_addk_i32 s28, 5120
  s_waitcnt vmcnt(4)
  buffer_load_dwordx4 a[40:43], v3, s[24:27], s28 offen nt
  s_addk_i32 s28, 5120
  s_waitcnt vmcnt(4)
  buffer_load_dwordx4 a[44:47], v3, s[24:27], s28 offen nt
L_proj:
  v_and_b32 v5, 8, v1
  v_and_b32 v6, 48, v1
  v_lshl_add_u32 v5, v5, 5, v6
  v_lshrrev_b32 v6, 5, v1
  v_mul_u32_u24 v6, 343552, v6
L_hop_32:
  s_cbranch_execz L_hop_33
  v_lshl_add_u32 v6, v1, 4, v6
  s_lshr_b32 s47, s4, 4
  s_mul_i32 s47, s47, 688128
  s_and_b32 s48, s2, 127
  s_mul_i32 s48, s48, 2688
  s_add_u32 s47, s47, s48
  s_lshl_b32 s48, s5, 9
  s_add_u32 s47, s47, s48
  s_mov_b32 s52, 0x07060500
  s_mov_b32 s53, 0x07060501
  s_mov_b32 s54, 0x07060502
  s_mov_b32 s55, 0x07060503
  s_waitcnt lgkmcnt(0)
  s_barrier
  ds_read_b128 v[60:63], v5 offset:320
  ds_read_b128 v[64:67], v5 offset:384
  ds_read_b128 v[68:71], v5 offset:448
  ds_read_b128 v[72:75], v5 offset:512
L_hop_33:
  s_cbranch_execz L_hop_34
  s_waitcnt lgkmcnt(0)
  v_and_b32 v76, v60, v16
  v_and_b32 v77, v60, v17
  v_and_b32 v78, v60, v18
  v_and_b32 v79, v60, v19
  v_and_b32 v80, v64, v16
  v_and_b32 v81, v64, v17
  v_and_b32 v82, v64, v18
  v_and_b32 v83, v64, v19
  s_waitcnt vmcnt(11)
  v_mfma_f32_16x16x32_bf16 v[48:51], v[76:79], a[0:3], 0
  v_and_b32 v84, v68, v16
  v_and_b32 v85, v68, v17
  v_and_b32 v86, v68, v18
  v_and_b32 v87, v68, v19
  s_waitcnt vmcnt(10)
  v_mfma_f32_16x16x32_bf16 v[48:51], v[80:83], a[4:7], v[48:51]
  v_and_b32 v88, v72, v16
  v_and_b32 v89, v72, v17
  v_and_b32 v90, v72, v18
  v_and_b32 v91, v72, v19
  s_waitcnt vmcnt(9)
  v_mfma_f32_16x16x32_bf16 v[48:51], v[84:87], a[8:11], v[48:51]
  v_and_b32 v92, v61, v16
  v_and_b32 v93, v61, v17
  v_and_b32 v94, v61, v18
L_hop_34:
  s_cbranch_execz L_hop_35
  v_and_b32 v95, v61, v19
  v_and_b32 v96, v65, v16
  v_and_b32 v97, v65, v17
  v_and_b32 v98, v65, v18
  v_and_b32 v99, v65, v19
  s_waitcnt vmcnt(8)
  v_mfma_f32_16x16x32_bf16 v[48:51], v[88:91], a[12:15], v[48:51]
  v_and_b32 v100, v69, v16
  v_and_b32 v101, v69, v17
  v_and_b32 v102, v69, v18
  v_and_b32 v103, v69, v19
  v_and_b32 v104, v73, v16
  v_and_b32 v105, v73, v17
  v_and_b32 v106, v73, v18
  v_and_b32 v107, v73, v19
  s_waitcnt vmcnt(7)
  v_mfma_f32_16x16x32_bf16 v[48:51], v[92:95], a[16:19], v[48:51]
  v_and_b32 v108, v62, v16
  v_and_b32 v109, v62, v17
  v_and_b32 v110, v62, v18
  v_and_b32 v111, v62, v19
  v_and_b32 v112, v66, v16
  v_and_b32 v113, v66, v17
  v_and_b32 v114, v66, v18
  v_and_b32 v115, v66, v19
  s_waitcnt vmcnt(6)
  v_mfma_f32_16x16x32_bf16 v[48:51], v[96:99], a[20:23], v[48:51]
L_hop_35:
  s_cbranch_execz L_hop_36
  v_and_b32 v116, v70, v16
  v_and_b32 v117, v70, v17
  v_and_b32 v118, v70, v18
  v_and_b32 v119, v70, v19
  v_and_b32 v120, v74, v16
  v_and_b32 v121, v74, v17
  v_and_b32 v122, v74, v18
  v_and_b32 v123, v74, v19
  s_waitcnt vmcnt(5)
  v_mfma_f32_16x16x32_bf16 v[48:51], v[100:103], a[24:27], v[48:51]
  s_waitcnt vmcnt(4)
  v_mfma_f32_16x16x32_bf16 v[48:51], v[104:107], a[28:31], v[48:51]
  s_waitcnt vmcnt(3)
  v_mfma_f32_16x16x32_bf16 v[48:51], v[108:111], a[32:35], v[48:51]
  s_waitcnt vmcnt(2)
  v_mfma_f32_16x16x32_bf16 v[48:51], v[112:115], a[36:39], v[48:51]
  s_waitcnt vmcnt(1)
  v_mfma_f32_16x16x32_bf16 v[48:51], v[116:119], a[40:43], v[48:51]
  s_waitcnt vmcnt(0)
  v_mfma_f32_16x16x32_bf16 v[48:51], v[120:123], a[44:47], v[48:51]
  s_nop 7
  v_perm_b32 v48, v48, v63, s52
L_hop_36:
  s_cbranch_execz L_hop_37
  v_perm_b32 v49, v49, v63, s53
  v_perm_b32 v50, v50, v63, s54
  v_perm_b32 v51, v51, v63, s55
  buffer_store_dwordx4 v[48:51], v6, s[36:39], s47 offen sc1
  s_waitcnt vmcnt(0)
  s_barrier
  s_cmp_eq_u32 s5, 4
  s_cbranch_scc1 L_final
L_end:
  s_endpgm
L_helper:
  v_mov_b32 v60, 0
  v_mov_b32 v61, 0
  v_mov_b32 v62, 0
  v_mov_b32 v63, 0
  v_mov_b32 v64, -1
  ds_write_b128 v4, v[60:63] offset:16
  ds_write_b32 v4, v64 offset:32
  s_mov_b32 s36, s42
  s_mov_b32 s37, s43
  s_mov_b32 s38, 836768768
  s_mov_b32 s39, 0x20000
  v_and_b32 v5, 1, v7
  v_lshlrev_b32 v5, 4, v5
  v_mov_b32 v8, 0xffff
  v_lshlrev_b32 v5, v5, v8
  v_lshrrev_b32 v8, 1, v7
  v_cmp_eq_u32 vcc, 0, v8
  s_nop 1
  v_cndmask_b32 v16, 0, v5, vcc
  v_cmp_eq_u32 vcc, 1, v8
  s_nop 1
  v_cndmask_b32 v17, 0, v5, vcc
  v_cmp_eq_u32 vcc, 2, v8
  s_nop 1
  v_cndmask_b32 v18, 0, v5, vcc
  v_cmp_eq_u32 vcc, 3, v8
  s_nop 1
  v_cndmask_b32 v19, 0, v5, vcc
  s_cmp_ge_u32 s4, 16
  s_cselect_b32 s24, s82, s72
  s_cselect_b32 s25, s83, s73
  s_lshr_b32 s47, s4, 2
  s_and_b32 s47, s47, 3
  s_lshl_b32 s47, s47, 3
  s_add_u32 s47, s47, s3
  s_mul_i32 s47, s47, 12
  s_and_b32 s48, s4, 3
  s_add_u32 s47, s47, s48
  s_mul_i32 s47, s47, 20480
  s_lshl_b32 s48, s5, 8
  s_add_u32 s28, s47, s48
  v_lshrrev_b32 v3, 4, v1
  v_mul_u32_u24 v3, 1280, v3
  v_and_b32 v8, 15, v1
  v_lshl_add_u32 v3, v8, 4, v3
  s_mov_b32 s26, 7864320
  s_mov_b32 s27, 0x20000
  v_lshlrev_b32 v5, 3, v1
  v_lshlrev_b32 v8, 4, v1
  v_lshlrev_b32 v10, 2, v1
  s_mul_i32 s12, s3, 12288
  s_add_u32 s12, s12, 6291456
  s_and_b32 s13, s4, 7
  s_mul_i32 s13, s13, 3
  s_lshr_b32 s14, s4, 3
  s_add_u32 s13, s13, s14
  s_lshl_b32 s13, s13, 9
  s_add_u32 s13, s13, s12
  s_add_u32 s14, s12, 4096
  s_add_u32 s15, s12, 8192
  s_bitcmp1_b32 s4, 3
  s_cselect_b32 s20, s68, s66
  s_cselect_b32 s21, s69, s67
  s_cselect_b32 s22, s78, s76
  s_cselect_b32 s23, s79, s77
  s_bitcmp1_b32 s4, 4
  s_cselect_b32 s20, s22, s20
  s_cselect_b32 s21, s23, s21
  s_and_b32 s47, s2, 63
  s_mul_i32 s47, s47, 3145728
  s_add_u32 s20, s20, s47
  s_addc_u32 s21, s21, 0
  s_load_dword s52, s[20:21], 0
  s_load_dword s53, s[20:21], 0xffffc
  s_add_u32 s22, s20, 0x200000
  s_addc_u32 s23, s21, 0
  s_load_dword s54, s[22:23], 0
  s_load_dword s55, s[22:23], 0xffffc
  s_add_u32 s16, s24, s28
  s_addc_u32 s17, s25, 0
  s_load_dword s56, s[16:17], 0
  s_add_u32 s18, s42, 2097148
  s_addc_u32 s19, s43, 0
  s_load_dword s57, s[18:19], 0
  s_load_dword s58, s[18:19], 184324
  s_add_u32 s30, s42, 6291452
  s_addc_u32 s31, s43, 0
  s_load_dword s59, s[30:31], 0
  s_load_dword s62, s[30:31], 0xf0004
  s_waitcnt lgkmcnt(0)
  s_cmp_eq_u32 s2, 0
  s_cbranch_scc1 L_nhave
  s_mov_b32 s50, 200000
L_nloop:
  buffer_load_dword v60, v4, s[8:11], 0 offen sc1
  s_waitcnt vmcnt(0)
  v_readfirstlane_b32 s46, v60
  s_sub_u32 s50, s50, 1
  s_cbranch_scc1 L_nhave
  s_cmp_lg_u32 s46, 0
  s_cbranch_scc1 L_nhave
  s_sleep 8
  s_branch L_nloop
L_nhave:
  s_waitcnt lgkmcnt(0)
  s_cmp_ge_u32 s4, 24
  s_cbranch_scc1 L_hq2
  s_barrier
  ds_read_b64 v[60:61], v5 offset:16896
  ds_read_b64 v[62:63], v5 offset:17408
  ds_read_b64 v[64:65], v5 offset:17920
  ds_read_b64 v[66:67], v5 offset:18432
  ds_read_b64 v[68:69], v5 offset:18944
  ds_read_b64 v[70:71], v5 offset:19456
  ds_read_b64 v[72:73], v5 offset:19968
  ds_read_b64 v[74:75], v5 offset:20480
  s_waitcnt lgkmcnt(6)
  v_add_f32 v60, v60, v62
  v_add_f32 v61, v61, v63
  s_waitcnt lgkmcnt(5)
  v_add_f32 v60, v60, v64
  v_add_f32 v61, v61, v65
  s_waitcnt lgkmcnt(4)
  v_add_f32 v60, v60, v66
  v_add_f32 v61, v61, v67
  s_waitcnt lgkmcnt(3)
  v_add_f32 v60, v60, v68
  v_add_f32 v61, v61, v69
  s_waitcnt lgkmcnt(2)
  v_add_f32 v60, v60, v70
  v_add_f32 v61, v61, v71
  s_waitcnt lgkmcnt(1)
  v_add_f32 v60, v60, v72
  v_add_f32 v61, v61, v73
  s_waitcnt lgkmcnt(0)
  v_add_f32 v60, v60, v74
  v_add_f32 v61, v61, v75
  v_cvt_pk_bf16_f32 v48, v60, v61
  v_mov_b32 v49, s46
  s_add_u32 s47, s13, 524288
  buffer_store_dwordx2 v[48:49], v5, s[36:39], s47 offen
L_hq2:
  v_and_b32 v6, 16, v1
  v_mul_u32_u24 v6, 96, v6
  v_and_b32 v7, 15, v1
  v_lshl_add_u32 v6, v7, 3, v6
  v_lshrrev_b32 v7, 5, v1
  v_lshl_add_u32 v6, v7, 7, v6
  s_mov_b32 s50, 200000
L_qg:
  s_cmp_lg_u32 s50, 199976
  s_cbranch_scc1 L_qg1
  s_cmp_ge_u32 s4, 24
  s_cbranch_scc1 L_qg1
  buffer_store_dwordx2 v[48:49], v5, s[36:39], s13 offen sc1
L_qg1:
  s_cmp_gt_u32 s50, 199976
  s_cselect_b32 s47, 524288, 0
  s_bitcmp1_b32 s50, 0
  s_cselect_b32 s47, 524288, s47
  v_add_u32 v11, s47, v8
  buffer_load_dwordx4 v[60:63], v11, s[36:39], s12 offen offset:0 sc1
  buffer_load_dwordx4 v[64:67], v11, s[36:39], s12 offen offset:1024 sc1
  buffer_load_dwordx4 v[68:71], v11, s[36:39], s12 offen offset:2048 sc1
  buffer_load_dwordx4 v[72:75], v11, s[36:39], s12 offen offset:3072 sc1
  buffer_load_dwordx4 v[76:79], v11, s[36:39], s14 offen offset:0 sc1
  buffer_load_dwordx4 v[80:83], v11, s[36:39], s14 offen offset:1024 sc1
  buffer_load_dwordx4 v[84:87], v11, s[36:39], s14 offen offset:2048 sc1
  buffer_load_dwordx4 v[88:91], v11, s[36:39], s14 offen offset:3072 sc1
  buffer_load_dwordx4 v[92:95], v11, s[36:39], s15 offen offset:0 sc1
  buffer_load_dwordx4 v[96:99], v11, s[36:39], s15 offen offset:1024 sc1
  buffer_load_dwordx4 v[100:103], v11, s[36:39], s15 offen offset:2048 sc1
  buffer_load_dwordx4 v[104:107], v11, s[36:39], s15 offen offset:3072 sc1
  s_mov_b64 s[48:49], 0
  s_waitcnt vmcnt(11)
  v_cmp_ne_u32 vcc, s46, v61
  s_or_b64 s[48:49], s[48:49], vcc
  v_cmp_ne_u32 vcc, s46, v63
  s_or_b64 s[48:49], s[48:49], vcc
  s_waitcnt vmcnt(10)
  v_cmp_ne_u32 vcc, s46, v65
  s_or_b64 s[48:49], s[48:49], vcc
  v_cmp_ne_u32 vcc, s46, v67
  s_or_b64 s[48:49], s[48:49], vcc
  s_waitcnt vmcnt(9)
  v_cmp_ne_u32 vcc, s46, v69
  s_or_b64 s[48:49], s[48:49], vcc
  v_cmp_ne_u32 vcc, s46, v71
  s_or_b64 s[48:49], s[48:49], vcc
  s_waitcnt vmcnt(8)
  v_cmp_ne_u32 vcc, s46, v73
  s_or_b64 s[48:49], s[48:49], vcc
  v_cmp_ne_u32 vcc, s46, v75
  s_or_b64 s[48:49], s[48:49], vcc
  s_waitcnt vmcnt(7)
  v_cmp_ne_u32 vcc, s46, v77
  s_or_b64 s[48:49], s[48:49], vcc
  v_cmp_ne_u32 vcc, s46, v79
  s_or_b64 s[48:49], s[48:49], vcc
  s_waitcnt vmcnt(6)
  v_cmp_ne_u32 vcc, s46, v81
  s_or_b64 s[48:49], s[48:49], vcc
  v_cmp_ne_u32 vcc, s46, v83
  s_or_b64 s[48:49], s[48:49], vcc
  s_waitcnt vmcnt(5)
  v_cmp_ne_u32 vcc, s46, v85
  s_or_b64 s[48:49], s[48:49], vcc
  v_cmp_ne_u32 vcc, s46, v87
  s_or_b64 s[48:49], s[48:49], vcc
  s_waitcnt vmcnt(4)
  v_cmp_ne_u32 vcc, s46, v89
  s_or_b64 s[48:49], s[48:49], vcc
  v_cmp_ne_u32 vcc, s46, v91
  s_or_b64 s[48:49], s[48:49], vcc
  s_waitcnt vmcnt(3)
  v_cmp_ne_u32 vcc, s46, v93
  s_or_b64 s[48:49], s[48:49], vcc
  v_cmp_ne_u32 vcc, s46, v95
  s_or_b64 s[48:49], s[48:49], vcc
  s_waitcnt vmcnt(2)
  v_cmp_ne_u32 vcc, s46, v97
  s_or_b64 s[48:49], s[48:49], vcc
  v_cmp_ne_u32 vcc, s46, v99
  s_or_b64 s[48:49], s[48:49], vcc
  s_waitcnt vmcnt(1)
  v_cmp_ne_u32 vcc, s46, v101
  s_or_b64 s[48:49], s[48:49], vcc
  v_cmp_ne_u32 vcc, s46, v103
  s_or_b64 s[48:49], s[48:49], vcc
  s_waitcnt vmcnt(0)
  v_cmp_ne_u32 vcc, s46, v105
  s_or_b64 s[48:49], s[48:49], vcc
  v_cmp_ne_u32 vcc, s46, v107
  s_or_b64 s[48:49], s[48:49], vcc
  s_sub_u32 s50, s50, 1
  s_cbranch_scc1 L_qgo
  s_cmp_eq_u64 s[48:49], 0
  s_cbranch_scc0 L_qg
L_qgo:
  v_mov_b32 v61, v62
  ds_write_b64 v6, v[60:61] offset:1600
  v_mov_b32 v65, v66
  ds_write_b64 v6, v[64:65] offset:1856
  v_mov_b32 v69, v70
  ds_write_b64 v6, v[68:69] offset:2112
  v_mov_b32 v73, v74
  ds_write_b64 v6, v[72:73] offset:2368
  v_mov_b32 v77, v78
  ds_write_b64 v6, v[76:77] offset:2624
  v_mov_b32 v81, v82
  ds_write_b64 v6, v[80:81] offset:2880
  v_mov_b32 v85, v86
  ds_write_b64 v6, v[84:85] offset:4672
  v_mov_b32 v89, v90
  ds_write_b64 v6, v[88:89] offset:4928
  v_mov_b32 v93, v94
  ds_write_b64 v6, v[92:93] offset:5184
  v_mov_b32 v97, v98
  ds_write_b64 v6, v[96:97] offset:5440
  v_mov_b32 v101, v102
  ds_write_b64 v6, v[100:101] offset:5696
  v_mov_b32 v105, v106
  ds_write_b64 v6, v[104:105] offset:5952
  s_waitcnt lgkmcnt(0)
  buffer_load_dwordx4 a[0:3], v3, s[24:27], s28 offen nt
  s_addk_i32 s28, 5120
  buffer_load_dwordx4 a[4:7], v3, s[24:27], s28 offen nt
  s_addk_i32 s28, 5120
  buffer_load_dwordx4 a[8:11], v3, s[24:27], s28 offen nt
  s_addk_i32 s28, 5120
  buffer_load_dwordx4 a[12:15], v3, s[24:27], s28 offen nt
  s_add_u32 s28, s28, 66560
  buffer_load_dwordx4 a[16:19], v3, s[24:27], s28 offen nt
  s_addk_i32 s28, 5120
  buffer_load_dwordx4 a[20:23], v3, s[24:27], s28 offen nt
  s_addk_i32 s28, 5120
  buffer_load_dwordx4 a[24:27], v3, s[24:27], s28 offen nt
  s_addk_i32 s28, 5120
  buffer_load_dwordx4 a[28:31], v3, s[24:27], s28 offen nt
  s_add_u32 s28, s28, 66560
  buffer_load_dwordx4 a[32:35], v3, s[24:27], s28 offen nt
  s_addk_i32 s28, 5120
  buffer_load_dwordx4 a[36:39], v3, s[24:27], s28 offen nt
  s_addk_i32 s28, 5120
  buffer_load_dwordx4 a[40:43], v3, s[24:27], s28 offen nt
  s_addk_i32 s28, 5120
  buffer_load_dwordx4 a[44:47], v3, s[24:27], s28 offen nt
  s_barrier
  s_getreg_b32 s56, hwreg(HW_REG_XCC_ID)
  s_and_b32 s56, s56, 7
  s_lshl_b32 s57, s56, 3
  s_add_u32 s57, s57, s3
  s_mul_i32 s57, s57, 1152
  s_add_u32 s57, s57, 6553600
  s_lshl_b32 s59, s4, 3
  s_add_u32 s59, s59, s57
  s_mov_b32 s31, 0
  v_mov_b32 v51, s46
  s_mov_b32 s18, -1
  s_mov_b32 s19, 1
  s_mov_b32 s30, 0
  s_mov_b32 s32, 0
  v_add_u32 v11, 20992, v10
  v_mov_b32 v12, 832
  s_mov_b32 s33, 0xffff
  s_mov_b32 s62, 124
  s_mov_b32 s29, 8
  s_mov_b32 s80, 0
  s_mov_b32 s81, 0
  s_mul_i32 s58, s3, 327680
  s_mul_i32 s48, s4, 640
  s_add_u32 s58, s58, s48
  s_add_u32 s58, s58, 2097152
  v_and_b32 v15, 1, v1
  v_lshlrev_b32 v15, 4, v15
  v_lshrrev_b32 v15, v15, s46
  v_lshlrev_b32 v15, 16, v15
  s_mov_b32 s45, s46
  s_mov_b32 s44, 16
  s_call_b64 s[60:61], L_pace
  s_mov_b64 exec, 0
  s_branch L_hop_0
L_back:
  s_load_dwordx2 s[6:7], s[0:1], 80
  s_waitcnt lgkmcnt(0)
  s_cmp_eq_u32 s31, 1
  s_cbranch_scc1 L_qg2
  s_cmp_ge_u32 s4, 24
  s_cbranch_scc1 L_qg2
  buffer_store_dwordx2 v[48:49], v5, s[36:39], s13 offen sc1
L_qg2:
  s_mov_b32 s44, 165
  s_call_b64 s[60:61], L_pace
  s_mov_b32 s34, 0x00ff
  s_call_b64 s[60:61], L_ml
  s_mov_b32 s32, 8
  s_mov_b32 s44, 184
  s_call_b64 s[60:61], L_pace
  s_mov_b32 s32, 8
  s_call_b64 s[60:61], L_drain
  s_cmp_ge_u32 s4, 16
  s_cbranch_scc1 L_s1
  s_mov_b32 s34, 0
  s_call_b64 s[60:61], L_wt
  s_call_b64 s[60:61], L_merge
  s_mov_b32 s34, 1
  s_call_b64 s[60:61], L_merge
L_s1:
  s_mov_b32 s44, 193
  s_call_b64 s[60:61], L_pace
  s_mov_b32 s34, 0xff00
  s_call_b64 s[60:61], L_ml
  s_mov_b32 s44, 198
  s_call_b64 s[60:61], L_pace
  s_mov_b32 s34, 8
  s_call_b64 s[60:61], L_wt
  s_xor_b32 s45, s46, 0x5aa5c33c
  v_and_b32 v15, 1, v1
  v_lshlrev_b32 v15, 4, v15
  v_lshrrev_b32 v15, v15, s45
  v_lshlrev_b32 v15, 16, v15
  s_sub_u32 s58, s58, 163840
  s_mov_b32 s32, 15
  s_mov_b32 s44, 229
  s_call_b64 s[60:61], L_pace
  s_mov_b32 s32, 12
  s_call_b64 s[60:61], L_drain
  s_mov_b32 s32, 15
  s_cmp_lt_u32 s4, 16
  s_cbranch_scc1 L_s4
  s_mov_b32 s34, 0
  s_call_b64 s[60:61], L_merge
L_s4:
  s_mov_b32 s34, 1
  s_mov_b32 s44, 244
  s_call_b64 s[60:61], L_pace
  s_and_b32 s20, s2, 3
  s_lshr_b32 s21, s2, 4
  s_lshl_b32 s21, s21, 2
  s_and_b32 s22, s2, 4
  s_lshr_b32 s22, s22, 1
  s_or_b32 s21, s21, s22
  s_and_b32 s22, s4, 1
  s_or_b32 s21, s21, s22
  v_lshrrev_b32 v13, 2, v1
  v_and_b32 v14, 3, v1
  v_mul_u32_u24 v13, 2688, v13
  v_lshl_add_u32 v13, v14, 4, v13
  v_lshlrev_b32 v14, 4, v14
  v_bfe_u32 v6, v1, 4, 1
  v_lshl_add_u32 v14, v6, 2, v14
  v_lshrrev_b32 v6, 5, v1
  v_lshl_add_u32 v14, v6, 1, v14
  s_mul_i32 s72, s20, 344064
  s_lshl_b32 s22, s21, 6
  s_add_u32 s72, s72, s22
  s_add_u32 s73, s72, 43008
  s_add_u32 s74, s72, 86016
  s_add_u32 s75, s72, 129024
  s_add_u32 s76, s72, 172032
  s_add_u32 s77, s72, 215040
  s_add_u32 s78, s72, 258048
  s_add_u32 s79, s72, 301056
  s_and_b32 s22, s20, 1
  s_mul_i32 s35, s22, 2560
  s_lshr_b32 s22, s20, 1
  s_mul_i32 s22, s22, 1280
  s_add_u32 s35, s35, s22
  s_lshr_b32 s22, s21, 3
  s_lshl_b32 s22, s22, 8
  s_add_u32 s35, s35, s22
  s_and_b32 s22, s21, 3
  s_lshl_b32 s22, s22, 6
  s_add_u32 s35, s35, s22
  s_and_b32 s22, s21, 4
  s_lshl_b32 s22, s22, 1
  s_add_u32 s35, s35, s22
  s_mov_b32 s12, s6
  s_mov_b32 s13, s7
  s_mov_b32 s14, 5120
  s_mov_b32 s15, 0x20000
  s_mov_b32 s32, 16
  s_call_b64 s[60:61], L_drain
  s_cmp_lt_u32 s4, 16
  s_cbranch_scc1 L_s3
  s_call_b64 s[60:61], L_merge
L_s3:
  s_branch L_proj
L_pace:
  s_sleep 24
  s_memrealtime s[22:23]
  ds_read_b128 v[60:63], v4 offset:16
  s_waitcnt lgkmcnt(0)
  v_min3_u32 v64, v60, v61, v62
  v_min_u32 v64, v64, v63
  v_add3_u32 v65, v60, v61, v62
  v_add_u32 v65, v65, v63
  v_readfirstlane_b32 s20, v64
  s_cmp_ge_u32 s20, s44
  s_cbranch_scc1 L_ret
  v_readfirstlane_b32 s21, v65
  s_mul_i32 s22, s22, 205
  s_lshr_b32 s22, s22, 6
  s_lshl_b32 s21, s21, 5
  s_sub_u32 s21, s21, s22
  s_and_b32 s21, s21, 0xffff
  v_mov_b32 v50, s21
  v_mov_b32 v68, 0
  v_mov_b32 v69, 0
  s_mov_b64 exec, 1
  buffer_store_dwordx2 v[50:51], v4, s[36:39], s59 offen
  s_mov_b64 exec, s[18:19]
  buffer_load_dwordx2 v[68:69], v5, s[36:39], s57 offen sc1
  s_mov_b64 exec, -1
  s_waitcnt vmcnt(0)
  v_readlane_b32 s22, v68, 32
  v_cmp_eq_u32 vcc, s46, v69
  v_subrev_u32 v67, s21, v68
  v_bfe_i32 v67, v67, 0, 16
  v_cndmask_b32 v67, 0, v67, vcc
  s_cmp_eq_u32 vcc_lo, -1
  s_cselect_b32 s31, 1, s31
  s_nop 1
  v_add_u32_dpp v67, v67, v67 row_ror:1 row_mask:0xf bank_mask:0xf
  s_nop 1
  v_add_u32_dpp v67, v67, v67 row_ror:2 row_mask:0xf bank_mask:0xf
  s_nop 1
  v_add_u32_dpp v67, v67, v67 row_ror:4 row_mask:0xf bank_mask:0xf
  s_nop 1
  v_add_u32_dpp v67, v67, v67 row_ror:8 row_mask:0xf bank_mask:0xf
  s_bitcmp1_b32 vcc_hi, 0
  s_cselect_b32 s22, s22, 0
  v_readlane_b32 s23, v67, 0
  v_readlane_b32 s47, v67, 16
  s_add_u32 s23, s23, s47
  s_ashr_i32 s23, s23, 5
  s_add_u32 s23, s23, s21
  s_add_u32 s47, s23, s22
  s_and_b32 s47, s47, 0xffff
  v_mov_b32 v66, s47
  ds_write_b32 v4, v66 offset:32
  s_cmp_lg_u32 s4, 0
  s_cbranch_scc1 L_paced
  s_ashr_i32 s48, s22, 2
  s_sub_u32 s48, s22, s48
  s_mov_b64 exec, 1
  s_cmp_lt_u32 s20, s29
  s_cbranch_scc1 L_ep1
  s_add_u32 s29, s29, 40
  s_cmp_gt_u32 s29, 215
  s_cselect_b32 s29, 999, s29
  s_mov_b32 s81, 2
  s_and_b32 s80, s23, 0xffff
  s_add_u32 s62, s62, 4
  s_or_b32 s47, s80, 0x1000000
  v_mov_b32 v66, s47
  buffer_atomic_add v66, v4, s[8:11], s62 offen
  s_branch L_dst
L_ep1:
  s_sub_u32 s81, s81, 1
  s_cmp_lg_u32 s81, 0
  s_cbranch_scc1 L_dst
  s_load_dword s64, s[40:41], s62 glc
  s_waitcnt lgkmcnt(0)
  s_lshr_b32 s65, s64, 24
  s_mul_i32 s65, s65, s80
  s_sub_u32 s48, s64, s65
  s_sext_i32_i16 s48, s48
  s_ashr_i32 s48, s48, 3
L_dst:
  v_mov_b32 v50, s48
  buffer_store_dwordx2 v[50:51], v4, s[36:39], s57 offen offset:256
  s_mov_b64 exec, -1
L_paced:
  s_mov_b32 s63, 2
  s_branch L_fl
L_drain:
  s_mov_b32 s63, -1
L_fl:
  s_cmp_ge_u32 s30, 8
  s_cselect_b32 s48, 16, 8
  s_add_u32 s48, s48, s30
  s_lshl_b32 s48, s48, 3
  s_add_u32 s48, s48, 5
  s_cmp_lt_i32 s63, 0
  s_cbranch_scc0 L_fl0
  s_cmp_ge_u32 s30, s32
  s_cbranch_scc0 L_fl1
L_ret:
  s_setpc_b64 s[60:61]
L_fl0:
  s_cmp_ge_u32 s30, s32
  s_cbranch_scc1 L_pace
  s_cmp_lt_u32 s20, s48
  s_cbranch_scc1 L_pace
  s_sub_u32 s63, s63, 1
  s_cbranch_scc1 L_pace
L_fl1:
  ds_read_b128 v[88:91], v12
L_flw:
  ds_read_b128 v[60:63], v4 offset:16
  s_waitcnt lgkmcnt(0)
  v_min3_u32 v64, v60, v61, v62
  v_min_u32 v64, v64, v63
  s_nop 0
  v_readfirstlane_b32 s20, v64
  s_cmp_lt_u32 s20, s48
  s_cbranch_scc1 L_flw
  ds_read2st64_b32 v[60:61], v11 offset0:0 offset1:1
  ds_read2st64_b32 v[62:63], v11 offset0:2 offset1:3
  ds_read2st64_b32 v[64:65], v11 offset0:4 offset1:5
  ds_read2st64_b32 v[66:67], v11 offset0:6 offset1:7
  ds_read2st64_b32 v[68:69], v11 offset0:8 offset1:9
  ds_read2st64_b32 v[70:71], v11 offset0:10 offset1:11
  ds_read2st64_b32 v[72:73], v11 offset0:12 offset1:13
  ds_read2st64_b32 v[74:75], v11 offset0:14 offset1:15
  ds_read2st64_b32 v[76:77], v11 offset0:16 offset1:17
  ds_read2st64_b32 v[78:79], v11 offset0:18 offset1:19
  ds_read2st64_b32 v[80:81], v11 offset0:20 offset1:21
  ds_read2st64_b32 v[82:83], v11 offset0:22 offset1:23
  s_waitcnt lgkmcnt(9)
  v_add_f32 v60, v60, v63
  v_add_f32 v61, v61, v64
  v_add_f32 v62, v62, v65
  v_mul_f32 v92, v88, v60
  v_mul_f32 v93, v88, v61
  v_mul_f32 v94, v88, v62
  s_waitcnt lgkmcnt(6)
  v_add_f32 v66, v66, v69
  v_add_f32 v67, v67, v70
  v_add_f32 v68, v68, v71
  v_fmac_f32 v92, v89, v66
  v_fmac_f32 v93, v89, v67
  v_fmac_f32 v94, v89, v68
  s_waitcnt lgkmcnt(3)
  v_add_f32 v72, v72, v75
  v_add_f32 v73, v73, v76
  v_add_f32 v74, v74, v77
  v_fmac_f32 v92, v90, v72
  v_fmac_f32 v93, v90, v73
  v_fmac_f32 v94, v90, v74
  s_waitcnt lgkmcnt(0)
  v_add_f32 v78, v78, v81
  v_add_f32 v79, v79, v82
  v_add_f32 v80, v80, v83
  v_fmac_f32 v92, v91, v78
  v_fmac_f32 v93, v91, v79
  v_fmac_f32 v94, v91, v80
  v_cvt_pk_bf16_f32 v92, v92, v93
  v_cvt_pk_bf16_f32 v93, v94, v94
  v_and_or_b32 v93, v93, s33, v15
  s_cmp_eq_u32 s31, 1
  s_cbranch_scc1 L_poa
  buffer_store_dwordx2 v[92:93], v5, s[36:39], s58 offen sc1
  s_branch L_pob
L_poa:
  buffer_store_dwordx2 v[92:93], v5, s[36:39], s58 offen
L_pob:
  v_add_u32 v11, 6144, v11
  v_add_u32 v12, 16, v12
  s_add_u32 s58, s58, 20480
  s_add_u32 s30, s30, 1
  s_branch L_fl
L_ml:
  v_and_b32 v6, 15, v1
  v_lshlrev_b32 v7, 5, v6
  v_lshlrev_b32 v6, 4, v6
  ds_read_b128 v[60:63], v7 offset:1088
  ds_read_b128 v[64:67], v7 offset:1104
  s_lshl_b32 s47, s3, 5
  s_add_u32 s47, s47, s4
  s_lshl_b32 s47, s47, 8
  s_add_u32 s47, s47, 6422528
  s_waitcnt lgkmcnt(0)
  v_max3_f32 v68, v60, v62, v64
  v_max_f32 v68, v68, v66
  v_sub_f32 v72, v60, v68
  v_sub_f32 v73, v62, v68
  v_sub_f32 v74, v64, v68
  v_sub_f32 v75, v66, v68
  v_exp_f32 v72, v72
  v_exp_f32 v73, v73
  v_exp_f32 v74, v74
  v_exp_f32 v75, v75
  v_mov_b32 v70, 0
  v_mov_b32 v71, s46
  v_mul_f32 v69, v72, v61
  v_fmac_f32 v69, v73, v63
  v_fmac_f32 v69, v74, v65
  v_fmac_f32 v69, v75, v67
  s_mov_b32 exec_lo, s34
  s_mov_b32 exec_hi, 0
  ds_write_b128 v6, v[72:75] offset:832
  s_cmp_eq_u32 s31, 1
  s_cbranch_scc1 L_pma
  buffer_store_dwordx4 v[68:71], v6, s[36:39], s47 offen sc1
  s_branch L_pmb
L_pma:
  buffer_store_dwordx4 v[68:71], v6, s[36:39], s47 offen
L_pmb:
  s_mov_b64 exec, -1
  s_setpc_b64 s[60:61]
L_wt:
  v_and_b32 v6, 31, v1
  v_lshlrev_b32 v6, 8, v6
  v_and_b32 v7, 32, v1
  v_lshl_add_u32 v6, v7, 1, v6
  s_lshr_b32 s48, s4, 2
  s_and_b32 s48, s48, 3
  s_add_u32 s47, s34, s48
  s_lshl_b32 s47, s47, 4
  s_lshl_b32 s48, s3, 13
  s_add_u32 s47, s47, s48
  s_add_u32 s47, s47, 6422528
  s_mov_b32 s50, 200000
L_wg:
  buffer_load_dwordx4 v[60:63], v6, s[36:39], s47 offen sc1
  s_waitcnt vmcnt(0)
  v_cmp_ne_u32 vcc, s46, v63
  s_sub_u32 s50, s50, 1
  s_cbranch_scc1 L_wgo
  s_cmp_eq_u64 vcc, 0
  s_cbranch_scc1 L_wgo
  s_sleep 16
  s_branch L_wg
L_wgo:
  v_mov_b32 v64, v60
  s_nop 1
  v_max_f32_dpp v64, v64, v64 row_ror:1 row_mask:0xf bank_mask:0xf
  s_nop 1
  v_max_f32_dpp v64, v64, v64 row_ror:2 row_mask:0xf bank_mask:0xf
  s_nop 1
  v_max_f32_dpp v64, v64, v64 row_ror:4 row_mask:0xf bank_mask:0xf
  s_nop 1
  v_max_f32_dpp v64, v64, v64 row_ror:8 row_mask:0xf bank_mask:0xf
  v_mov_b32 v65, v64
  s_nop 1
  v_permlane16_swap_b32 v64, v65
  s_nop 0
  v_max_f32 v64, v64, v65
  v_sub_f32 v60, v60, v64
  v_exp_f32 v60, v60
  s_nop 0
  v_mul_f32 v64, v60, v61
  s_nop 1
  v_add_f32_dpp v64, v64, v64 row_ror:1 row_mask:0xf bank_mask:0xf
  s_nop 1
  v_add_f32_dpp v64, v64, v64 row_ror:2 row_mask:0xf bank_mask:0xf
  s_nop 1
  v_add_f32_dpp v64, v64, v64 row_ror:4 row_mask:0xf bank_mask:0xf
  s_nop 1
  v_add_f32_dpp v64, v64, v64 row_ror:8 row_mask:0xf bank_mask:0xf
  v_mov_b32 v65, v64
  s_nop 1
  v_permlane16_swap_b32 v64, v65
  s_nop 0
  v_add_f32 v64, v64, v65
  v_rcp_f32 v64, v64
  v_and_b32 v6, 7, v1
  v_lshlrev_b32 v6, 4, v6
  v_lshl_add_u32 v6, v7, 2, v6
  v_and_b32 v7, 24, v1
  v_lshrrev_b32 v7, 1, v7
  v_add_u32 v6, v6, v7
  v_mul_f32 v60, v60, v64
  ds_write_b32 v6, v60 offset:64
  s_setpc_b64 s[60:61]
L_merge:
  v_lshrrev_b32 v6, 3, v1
  v_and_b32 v7, 7, v1
  v_mul_u32_u24 v9, 640, v6
  v_lshl_add_u32 v9, v7, 4, v9
  s_lshr_b32 s47, s4, 2
  s_and_b32 s47, s47, 3
  s_lshl_b32 s48, s34, 2
  s_add_u32 s47, s47, s48
  s_mul_i32 s47, s47, 20480
  s_mul_i32 s48, s3, 327680
  s_add_u32 s47, s47, s48
  s_and_b32 s48, s4, 3
  s_lshl_b32 s48, s48, 7
  s_add_u32 s47, s47, s48
  s_add_u32 s64, s47, 2097152
  s_add_u32 s65, s64, 5120
  s_add_u32 s66, s64, 10240
  s_add_u32 s67, s64, 15360
  s_lshl_b32 s48, s34, 7
  v_lshl_add_u32 v6, v6, 4, s48
  ds_read_b128 v[40:43], v6 offset:64
  s_mov_b32 s22, 0x07060302
  s_mov_b32 s23, 0xffff0000
  v_bfe_u32 v6, v1, 4, 1
  v_lshl_add_u32 v6, v7, 1, v6
  v_and_b32 v7, 32, v1
  v_lshlrev_b32 v6, 4, v6
  v_lshl_add_u32 v6, v7, 3, v6
  s_mov_b32 s50, 200000
L_gather:
  buffer_load_dwordx4 v[60:63], v9, s[36:39], s64 offen sc1
  buffer_load_dwordx4 v[64:67], v9, s[36:39], s65 offen sc1
  buffer_load_dwordx4 v[68:71], v9, s[36:39], s66 offen sc1
  buffer_load_dwordx4 v[72:75], v9, s[36:39], s67 offen sc1
  s_mov_b64 s[48:49], 0
  s_waitcnt vmcnt(3)
  v_perm_b32 v2, v63, v61, s22
  v_cmp_ne_u32 vcc, s45, v2
  s_or_b64 s[48:49], s[48:49], vcc
  s_waitcnt vmcnt(2)
  v_perm_b32 v2, v67, v65, s22
  v_cmp_ne_u32 vcc, s45, v2
  s_or_b64 s[48:49], s[48:49], vcc
  s_waitcnt vmcnt(1)
  v_perm_b32 v2, v71, v69, s22
  v_cmp_ne_u32 vcc, s45, v2
  s_or_b64 s[48:49], s[48:49], vcc
  s_waitcnt vmcnt(0)
  v_perm_b32 v2, v75, v73, s22
  v_cmp_ne_u32 vcc, s45, v2
  s_or_b64 s[48:49], s[48:49], vcc
  s_sub_u32 s50, s50, 1
  s_cbranch_scc1 L_ggo
  s_cmp_eq_u64 s[48:49], 0
  s_cbranch_scc0 L_gather
L_ggo:
  s_waitcnt lgkmcnt(0)
  v_lshlrev_b32 v2, 16, v60
  v_and_b32 v60, s23, v60
  v_lshlrev_b32 v61, 16, v61
  v_mul_f32 v92, v40, v2
  v_mul_f32 v93, v40, v60
  v_mul_f32 v94, v40, v61
  v_lshlrev_b32 v2, 16, v62
  v_and_b32 v62, s23, v62
  v_lshlrev_b32 v63, 16, v63
  v_mul_f32 v95, v40, v2
  v_mul_f32 v96, v40, v62
  v_mul_f32 v97, v40, v63
  v_lshlrev_b32 v2, 16, v64
  v_and_b32 v64, s23, v64
  v_lshlrev_b32 v65, 16, v65
  v_fmac_f32 v92, v41, v2
  v_fmac_f32 v93, v41, v64
  v_fmac_f32 v94, v41, v65
  v_lshlrev_b32 v2, 16, v66
  v_and_b32 v66, s23, v66
  v_lshlrev_b32 v67, 16, v67
  v_fmac_f32 v95, v41, v2
  v_fmac_f32 v96, v41, v66
  v_fmac_f32 v97, v41, v67
  v_lshlrev_b32 v2, 16, v68
  v_and_b32 v68, s23, v68
  v_lshlrev_b32 v69, 16, v69
  v_fmac_f32 v92, v42, v2
  v_fmac_f32 v93, v42, v68
  v_fmac_f32 v94, v42, v69
  v_lshlrev_b32 v2, 16, v70
  v_and_b32 v70, s23, v70
  v_lshlrev_b32 v71, 16, v71
  v_fmac_f32 v95, v42, v2
  v_fmac_f32 v96, v42, v70
  v_fmac_f32 v97, v42, v71
  v_lshlrev_b32 v2, 16, v72
  v_and_b32 v72, s23, v72
  v_lshlrev_b32 v73, 16, v73
  v_fmac_f32 v92, v43, v2
  v_fmac_f32 v93, v43, v72
  v_fmac_f32 v94, v43, v73
  v_lshlrev_b32 v2, 16, v74
  v_and_b32 v74, s23, v74
  v_lshlrev_b32 v75, 16, v75
  v_fmac_f32 v95, v43, v2
  v_fmac_f32 v96, v43, v74
  v_fmac_f32 v97, v43, v75
  s_cmp_eq_u32 s34, 0
  s_cbranch_scc0 L_fold
  v_mov_b32 v20, v92
  v_mov_b32 v21, v93
  v_mov_b32 v22, v94
  v_mov_b32 v23, v95
  v_mov_b32 v24, v96
  v_mov_b32 v25, v97
  s_setpc_b64 s[60:61]
L_fold:
  v_permlane32_swap_b32 v20, v92
  v_permlane32_swap_b32 v21, v93
  v_permlane32_swap_b32 v22, v94
  v_permlane32_swap_b32 v23, v95
  v_permlane32_swap_b32 v24, v96
  v_permlane32_swap_b32 v25, v97
  v_add_f32 v20, v20, v92
  v_add_f32 v21, v21, v93
  v_add_f32 v22, v22, v94
  v_add_f32 v23, v23, v95
  v_add_f32 v24, v24, v96
  v_add_f32 v25, v25, v97
  s_nop 0
  v_permlane16_swap_b32 v20, v23
  v_permlane16_swap_b32 v21, v24
  v_permlane16_swap_b32 v22, v25
  s_nop 0
  v_add_f32 v20, v20, v23
  v_add_f32 v21, v21, v24
  v_add_f32 v22, v22, v25
  v_add_f32_dpp v20, v20, v20 row_ror:8 row_mask:0xf bank_mask:0xf
  v_add_f32_dpp v21, v21, v21 row_ror:8 row_mask:0xf bank_mask:0xf
  v_add_f32_dpp v22, v22, v22 row_ror:8 row_mask:0xf bank_mask:0xf
  v_cvt_pk_bf16_f32 v20, v20, v20
  v_cvt_pk_bf16_f32 v21, v21, v21
  v_cvt_pk_bf16_f32 v22, v22, v22
  v_mov_b32 v23, s46
  ds_write_b128 v6, v[20:23] offset:320
  s_setpc_b64 s[60:61]
L_final:
  s_cmp_ge_u32 s2, 160
  s_cbranch_scc1 L_end
  s_mov_b32 s52, 0x0c0c0400
  s_mov_b32 s53, 0x04000c0c
  s_mov_b32 s54, 0xffffff00
  s_mov_b64 s[16:17], -1
  s_mov_b64 s[18:19], -1
  s_mov_b64 s[20:21], -1
  s_mov_b64 s[22:23], -1
  s_mov_b64 s[64:65], -1
  s_mov_b64 s[66:67], -1
  s_mov_b64 s[68:69], -1
  s_mov_b64 s[70:71], -1
  s_mov_b32 s50, 200000
L_fin:
  s_or_b64 exec, s[16:17], 1
  buffer_load_dwordx4 v[60:63], v13, s[36:39], s72 offen sc1
  s_or_b64 exec, s[18:19], 1
  buffer_load_dwordx4 v[64:67], v13, s[36:39], s73 offen sc1
  s_or_b64 exec, s[20:21], 1
  buffer_load_dwordx4 v[68:71], v13, s[36:39], s74 offen sc1
  s_or_b64 exec, s[22:23], 1
  buffer_load_dwordx4 v[72:75], v13, s[36:39], s75 offen sc1
  s_or_b64 exec, s[64:65], 1
  buffer_load_dwordx4 v[76:79], v13, s[36:39], s76 offen sc1
  s_or_b64 exec, s[66:67], 1
  buffer_load_dwordx4 v[80:83], v13, s[36:39], s77 offen sc1
  s_or_b64 exec, s[68:69], 1
  buffer_load_dwordx4 v[84:87], v13, s[36:39], s78 offen sc1
  s_or_b64 exec, s[70:71], 1
  buffer_load_dwordx4 v[88:91], v13, s[36:39], s79 offen sc1
  s_mov_b64 exec, -1
  s_waitcnt vmcnt(0)
  v_perm_b32 v40, v61, v60, s52
  v_perm_b32 v41, v63, v62, s53
  v_or_b32 v40, v40, v41
  v_cmp_ne_u32 s[16:17], s46, v40
  v_perm_b32 v40, v65, v64, s52
  v_perm_b32 v41, v67, v66, s53
  v_or_b32 v40, v40, v41
  v_cmp_ne_u32 s[18:19], s46, v40
  v_perm_b32 v40, v69, v68, s52
  v_perm_b32 v41, v71, v70, s53
  v_or_b32 v40, v40, v41
  v_cmp_ne_u32 s[20:21], s46, v40
  v_perm_b32 v40, v73, v72, s52
  v_perm_b32 v41, v75, v74, s53
  v_or_b32 v40, v40, v41
  v_cmp_ne_u32 s[22:23], s46, v40
  v_perm_b32 v40, v77, v76, s52
  v_perm_b32 v41, v79, v78, s53
  v_or_b32 v40, v40, v41
  v_cmp_ne_u32 s[64:65], s46, v40
  v_perm_b32 v40, v81, v80, s52
  v_perm_b32 v41, v83, v82, s53
  v_or_b32 v40, v40, v41
  v_cmp_ne_u32 s[66:67], s46, v40
  v_perm_b32 v40, v85, v84, s52
  v_perm_b32 v41, v87, v86, s53
  v_or_b32 v40, v40, v41
  v_cmp_ne_u32 s[68:69], s46, v40
  v_perm_b32 v40, v89, v88, s52
  v_perm_b32 v41, v91, v90, s53
  v_or_b32 v40, v40, v41
  v_cmp_ne_u32 s[70:71], s46, v40
  s_or_b64 s[48:49], s[16:17], s[18:19]
  s_or_b64 s[48:49], s[48:49], s[20:21]
  s_or_b64 s[48:49], s[48:49], s[22:23]
  s_or_b64 s[48:49], s[48:49], s[64:65]
  s_or_b64 s[48:49], s[48:49], s[66:67]
  s_or_b64 s[48:49], s[48:49], s[68:69]
  s_or_b64 s[48:49], s[48:49], s[70:71]
  s_sub_u32 s50, s50, 1
  s_cbranch_scc1 L_fgo
  s_cmp_eq_u64 s[48:49], 0
  s_cbranch_scc0 L_fin
L_fgo:
  v_and_b32 v92, s54, v60
  v_and_b32 v93, s54, v61
  v_and_b32 v94, s54, v62
  v_and_b32 v95, s54, v63
  v_and_b32 v96, s54, v64
  v_and_b32 v97, s54, v65
  v_and_b32 v98, s54, v66
  v_and_b32 v99, s54, v67
  v_and_b32 v100, s54, v68
  v_and_b32 v101, s54, v69
  v_and_b32 v102, s54, v70
  v_and_b32 v103, s54, v71
  v_and_b32 v104, s54, v72
  v_and_b32 v105, s54, v73
  v_and_b32 v106, s54, v74
  v_and_b32 v107, s54, v75
  v_and_b32 v108, s54, v76
  v_and_b32 v109, s54, v77
  v_and_b32 v110, s54, v78
  v_and_b32 v111, s54, v79
  v_and_b32 v112, s54, v80
  v_and_b32 v113, s54, v81
  v_and_b32 v114, s54, v82
  v_and_b32 v115, s54, v83
  v_and_b32 v116, s54, v84
  v_and_b32 v117, s54, v85
  v_and_b32 v118, s54, v86
  v_and_b32 v119, s54, v87
  v_and_b32 v120, s54, v88
  v_and_b32 v121, s54, v89
  v_and_b32 v122, s54, v90
  v_and_b32 v123, s54, v91
  v_pk_add_f32 v[92:93], v[92:93], v[108:109]
  v_pk_add_f32 v[94:95], v[94:95], v[110:111]
  v_pk_add_f32 v[96:97], v[96:97], v[112:113]
  v_pk_add_f32 v[98:99], v[98:99], v[114:115]
  v_pk_add_f32 v[100:101], v[100:101], v[116:117]
  v_pk_add_f32 v[102:103], v[102:103], v[118:119]
  v_pk_add_f32 v[104:105], v[104:105], v[120:121]
  v_pk_add_f32 v[106:107], v[106:107], v[122:123]
  v_pk_add_f32 v[92:93], v[92:93], v[100:101]
  v_pk_add_f32 v[94:95], v[94:95], v[102:103]
  v_pk_add_f32 v[96:97], v[96:97], v[104:105]
  v_pk_add_f32 v[98:99], v[98:99], v[106:107]
  v_pk_add_f32 v[92:93], v[92:93], v[96:97]
  v_pk_add_f32 v[94:95], v[94:95], v[98:99]
  s_nop 1
  v_permlane32_swap_b32 v92, v93
  v_permlane32_swap_b32 v94, v95
  s_nop 0
  v_add_f32 v92, v92, v93
  v_add_f32 v94, v94, v95
  s_nop 1
  v_permlane16_swap_b32 v92, v94
  s_nop 0
  v_add_f32 v92, v92, v94
  s_nop 1
  v_add_f32_dpp v92, v92, v92 row_ror:4 row_mask:0xf bank_mask:0xf
  s_nop 1
  v_add_f32_dpp v92, v92, v92 row_ror:8 row_mask:0xf bank_mask:0xf
  v_cvt_pk_bf16_f32 v92, v92, v92
  s_mov_b32 exec_lo, 0x000f000f
  s_mov_b32 exec_hi, 0x000f000f
  buffer_store_short v92, v14, s[12:15], s35 offen
  s_cmp_lg_u32 s2, 0
  s_cbranch_scc1 L_nz
  s_mov_b64 exec, -1
  buffer_store_dword v4, v10, s[8:11], 0 offen
L_nz:
  s_endpgm
L_hop_37:
  s_mov_b64 exec, -1
  s_branch L_back
.section .rodata,"a"
.p2align 6
.amdhsa_kernel concat_heads__gqa_block_cached__mha_block_cached__decode_kernel
  .amdhsa_next_free_vgpr 236
  .amdhsa_next_free_sgpr 102
  .amdhsa_accum_offset 156
  .amdhsa_group_segment_fixed_size 0
  .amdhsa_kernarg_size 104
  .amdhsa_user_sgpr_count 2
  .amdhsa_user_sgpr_kernarg_segment_ptr 1
  .amdhsa_system_sgpr_workgroup_id_x 1
.end_amdhsa_kernel
```
